```python
import torch

def _softmax(x, axis=-1):
    return torch.softmax(x, dim=axis)
def _gelu(x):
    return torch.nn.functional.gelu(x, approximate="tanh")
def _silu(x):
    return torch.nn.functional.silu(x)
def _sigmoid(x):
    return torch.sigmoid(x)
def _layernorm(x, axis=-1, eps=1e-5):
    m = x.mean(dim=axis, keepdim=True)
    v = x.var(dim=axis, keepdim=True, unbiased=False)
    return (x - m) / torch.sqrt(v + eps)
def _scatter_add(tgt, idx, src, axis=0):
    return tgt.clone().index_add_(axis, idx, src)
def _segment_sum(src, seg, n):
    out = torch.zeros((n,) + src.shape[1:], dtype=src.dtype)
    return out.index_add_(0, seg, src)
def _pad(x, pw):
    flat = tuple(v for pair in reversed(pw) for v in pair)
    return torch.nn.functional.pad(x, flat)

kernel_name = 'gated_mix__sliding_block_cached__dense_activation_relu__decode'

def setup_inputs():

    _w = (lambda a: (lambda t: t.to(torch.bfloat16) if t.is_floating_point() else t)(torch.as_tensor(a)))
    def _A_setup():
        B, Sq, D = 2, 1, 576
        Hq, Hkv, Sk, Dh = 32, 16, 8192, 128
        assert Hq % Hkv == 0, (Hq, Hkv)
        return {
            "x": _w((lambda *s: torch.randn(*s, dtype=torch.bfloat16) * 0.05)(B, Sq, D)),
            "k_cache": _w((lambda *s: torch.randn(*s, dtype=torch.bfloat16) * 6.4)(B, Hkv, Sk, Dh)),
            "v_cache": _w((lambda *s: torch.randn(*s, dtype=torch.bfloat16) * 1.6)(B, Hkv, Sk, Dh)),
            "wq": _w((lambda *s: torch.randn(*s, dtype=torch.bfloat16) * 6.4)(D, Hq * Dh) * (D ** -0.5)),
            "wo": _w((lambda *s: torch.randn(*s, dtype=torch.bfloat16) * 1.6)(Hq * Dh, D) * ((Hq * Dh) ** -0.5)),
        }
    _A_in = _A_setup()

    def _B_setup():
        B, S, D, Dff = 2, 1, 576, 4608
        return {
            "x": _w((lambda *s: torch.randn(*s, dtype=torch.bfloat16) * 0.05)(B, S, D)),
            "w1": _w((lambda *s: torch.randn(*s, dtype=torch.bfloat16) * 0.05)(D, Dff)),
            "w2": _w((lambda *s: torch.randn(*s, dtype=torch.bfloat16) * 0.05)(Dff, D)),
        }
    _B_in = _B_setup()

    return {
        "A_x": _A_in["x"],
        "A_k_cache": _A_in["k_cache"],
        "A_v_cache": _A_in["v_cache"],
        "A_wq": _A_in["wq"],
        "A_wo": _A_in["wo"],
        "B_x": _B_in["x"],
        "B_w1": _B_in["w1"],
        "B_w2": _B_in["w2"],
        "gate_w": _w((lambda *s: torch.randn(*s, dtype=torch.bfloat16) * 0.05)(576) * 16.0),
    }

def reference(A_x, A_k_cache, A_v_cache, A_wq, A_wo, B_x, B_w1, B_w2, gate_w):
    def _A_ref(x, k_cache, v_cache, wq, wo):
        B, Sq, D = x.shape
        Hq, Dh = 32, 128
        Hkv, Sk = k_cache.shape[1], k_cache.shape[2]
        W = min(4096, max(256, Sk // 4))
        rep = Hq // Hkv
        q = (lambda x, *d: x.permute(*d))((x @ wq).reshape(B, Sq, Hq, Dh), 0, 2, 1, 3)
        k = (lambda x, n, axis: torch.repeat_interleave(x, n, dim=axis))(k_cache[:, :, Sk - W:, :], rep, axis=1)
        v = (lambda x, n, axis: torch.repeat_interleave(x, n, dim=axis))(v_cache[:, :, Sk - W:, :], rep, axis=1)
        scores = torch.einsum("bhqd,bhkd->bhqk", q, k) * (Dh ** -0.5)
        p = _softmax(scores, axis=-1)
        o = torch.einsum("bhqk,bhkd->bhqd", p, v)
        return (lambda x, *d: x.permute(*d))(o, 0, 2, 1, 3).reshape(B, Sq, Hq * Dh) @ wo

    def _B_ref(x, w1, w2):
        h = torch.einsum("bsd,df->bsf", x, w1)
        zero = torch.zeros_like(h)
        h = torch.maximum(h, zero)
        return torch.einsum("bsf,fd->bsd", h, w2)

    x = A_x
    g = _sigmoid((x * gate_w).sum(-1, keepdims=True))
    a = _A_ref(x, A_k_cache, A_v_cache, A_wq, A_wo)
    b = _B_ref(x, B_w1, B_w2)
    return g * a + (1 - g) * b
```

```asm
; @launch grid=(256,1,1) block=(704,1,1) lds=114688
.amdgcn_target "amdgcn-amd-amdhsa--gfx950"
.text
.globl gated_mix__sliding_block_cached__dense_activation_relu__decode_kernel
.p2align 8
.type gated_mix__sliding_block_cached__dense_activation_relu__decode_kernel,@function
gated_mix__sliding_block_cached__dense_activation_relu__decode_kernel:
L_start:
    s_cmp_ge_u32 s2, 256
    s_cbranch_scc1 L_end
    s_load_dwordx8 s[20:27], s[0:1], 64
    v_lshrrev_b32 v1, 6, v0
    v_and_b32 v0, 63, v0
    s_and_b32 s28, s2, 7
    v_readfirstlane_b32 s3, v1
    s_lshl_b32 s28, s28, 5
    s_lshr_b32 s29, s2, 3
    s_add_u32 s28, s28, s29
    v_mov_b32 v1, 0
    v_lshrrev_b32 v3, 4, v0
    s_cmp_eq_u32 s3, 0
    s_cbranch_scc1 L_q1
    s_cmp_lt_u32 s3, 9
    s_cbranch_scc1 L_att
    s_getpc_b64 s[44:45]
L_pfbase:
    s_sub_u32 s44, s44, L_pfbase-L_start
    s_subb_u32 s45, s45, 0
    s_sub_u32 s34, s3, 9
    s_lshl_b32 s34, s34, 13
    v_lshl_add_u32 v2, v0, 7, s34
    v_min_u32 v2, L_end-L_start, v2
    global_load_dword v30, v2, s[44:45]
    s_load_dwordx2 s[48:49], s[0:1], 32
    s_load_dwordx4 s[52:55], s[0:1], 48
    s_barrier
    s_branch L_aux
L_q1:
    s_load_dwordx2 s[40:41], s[0:1], 0
    s_load_dwordx2 s[48:49], s[0:1], 24
    s_setprio 3
    v_lshlrev_b32 v2, 2, v0
    ds_write_b32 v2, v1
    v_lshrrev_b32 v4, 3, v0
    v_and_b32 v5, 7, v0
    v_and_b32 v6, 2, v4
    v_xor_b32 v5, v5, v6
    v_lshlrev_b32 v5, 4, v5
    v_xor_b32 v6, 64, v5
    v_lshl_add_u32 v17, v4, 13, v5
    v_lshl_add_u32 v18, v4, 13, v6
    v_lshlrev_b32 v16, 4, v0
    s_and_b32 s34, s28, 3
    s_mul_i32 s36, s34, 1179648
    s_lshr_b32 s35, s28, 2
    s_lshl_b32 s35, s35, 7
    s_add_u32 s36, s36, s35
    s_mov_b32 s42, 0x900
    s_mov_b32 s43, 0x20000
    s_mov_b32 s50, 0x480000
    s_mov_b32 s51, 0x20000
    s_mov_b32 m0, 2048
    s_waitcnt lgkmcnt(0)
    buffer_load_dwordx4 v16, s[40:43], 0 offen offset:0 lds
    buffer_load_dwordx4 v16, s[40:43], 0 offen offset:1024 lds
    buffer_load_dwordx4 v16, s[40:43], 0 offen offset:2048 lds
    s_mov_b32 m0, 20480
    s_load_dword s56, s[26:27], 0
    buffer_load_dwordx4 v17, s[48:51], s36 offen nt lds
    s_add_u32 m0, m0, 1024
    s_add_u32 s36, s36, 65536
    buffer_load_dwordx4 v18, s[48:51], s36 offen nt lds
    s_add_u32 m0, m0, 1024
    s_add_u32 s36, s36, 65536
    buffer_load_dwordx4 v17, s[48:51], s36 offen nt lds
    s_add_u32 m0, m0, 1024
    s_add_u32 s36, s36, 65536
    buffer_load_dwordx4 v18, s[48:51], s36 offen nt lds
    s_add_u32 m0, m0, 1024
    s_add_u32 s36, s36, 65536
    buffer_load_dwordx4 v17, s[48:51], s36 offen nt lds
    s_add_u32 m0, m0, 1024
    s_add_u32 s36, s36, 65536
    buffer_load_dwordx4 v18, s[48:51], s36 offen nt lds
    s_add_u32 m0, m0, 1024
    s_add_u32 s36, s36, 65536
    buffer_load_dwordx4 v17, s[48:51], s36 offen nt lds
    s_add_u32 m0, m0, 1024
    s_add_u32 s36, s36, 65536
    buffer_load_dwordx4 v18, s[48:51], s36 offen nt lds
    s_add_u32 m0, m0, 1024
    s_add_u32 s36, s36, 65536
    buffer_load_dwordx4 v17, s[48:51], s36 offen nt lds
    s_add_u32 m0, m0, 1024
    s_add_u32 s36, s36, 65536
    buffer_load_dwordx4 v18, s[48:51], s36 offen nt lds
    s_add_u32 m0, m0, 1024
    s_add_u32 s36, s36, 65536
    buffer_load_dwordx4 v17, s[48:51], s36 offen nt lds
    s_add_u32 m0, m0, 1024
    s_add_u32 s36, s36, 65536
    buffer_load_dwordx4 v18, s[48:51], s36 offen nt lds
    s_add_u32 m0, m0, 1024
    s_add_u32 s36, s36, 65536
    buffer_load_dwordx4 v17, s[48:51], s36 offen nt lds
    s_add_u32 m0, m0, 1024
    s_add_u32 s36, s36, 65536
    buffer_load_dwordx4 v18, s[48:51], s36 offen nt lds
    s_add_u32 m0, m0, 1024
    s_add_u32 s36, s36, 65536
    buffer_load_dwordx4 v17, s[48:51], s36 offen nt lds
    s_add_u32 m0, m0, 1024
    s_add_u32 s36, s36, 65536
    buffer_load_dwordx4 v18, s[48:51], s36 offen nt lds
    s_add_u32 m0, m0, 1024
    s_add_u32 s36, s36, 65536
    buffer_load_dwordx4 v17, s[48:51], s36 offen nt lds
    s_add_u32 m0, m0, 1024
    s_add_u32 s36, s36, 65536
    buffer_load_dwordx4 v18, s[48:51], s36 offen nt lds
    s_barrier
    v_mov_b32 v20, 0
    v_mov_b32 v21, 0
    v_mov_b32 v22, 0
    v_mov_b32 v23, 0
    ds_write_b128 v16, v[20:23] offset:38912
    ds_write_b128 v16, v[20:23] offset:39936
    s_lshr_b32 s29, s28, 4
    s_and_b32 s30, s28, 15
    s_mov_b32 s3, 8
    v_bfe_u32 v7, v0, 2, 2
    v_lshl_add_u32 v8, v3, 3, v7
    v_lshlrev_b32 v8, 7, v8
    v_and_b32 v9, 3, v0
    v_lshl_add_u32 v8, v9, 3, v8
    v_and_b32 v9, 1, v3
    v_lshlrev_b32 v9, 1, v9
    v_lshrrev_b32 v7, 1, v7
    v_or_b32 v9, v9, v7
    v_lshlrev_b32 v9, 5, v9
    v_xor_b32 v12, 0, v9
    v_add_u32 v12, v12, v8
    v_xor_b32 v13, 32, v9
    v_add_u32 v13, v13, v8
    v_xor_b32 v14, 64, v9
    v_add_u32 v14, v14, v8
    v_xor_b32 v15, 96, v9
    v_add_u32 v15, v15, v8
    v_lshrrev_b32 v10, 2, v0
    v_xor_b32 v10, v10, v0
    v_and_b32 v10, 1, v10
    s_waitcnt lgkmcnt(0)
    s_add_u32 s19, s56, 1
    s_and_b32 s57, s19, 0xff
    s_bfe_u32 s17, s19, 0x80008
    s_bfe_u32 s18, s19, 0x80010
    s_lshr_b32 s19, s19, 24
    s_xor_b32 s17, s17, s57
    s_xor_b32 s18, s18, s57
    s_xor_b32 s19, s19, s57
    s_mov_b32 s58, 0xffffff00
    v_mov_b32 v11, s57
    v_mov_b32 v58, s17
    v_mov_b32 v59, s18
    v_mov_b32 v60, s19
    v_and_b32 v16, 15, v0
    v_lshlrev_b32 v16, 4, v16
    v_lshl_add_u32 v17, v3, 12, v16
    s_lshl_b32 s34, s29, 13
    s_and_b32 s35, s28, 3
    s_lshl_b32 s35, s35, 10
    s_add_u32 s34, s34, s35
    s_bfe_u32 s35, s28, 0x20002
    s_lshl_b32 s35, s35, 8
    s_add_u32 s34, s34, s35
    s_add_u32 s44, s34, 0x1000
    s_add_u32 s44, s26, s44
    s_addc_u32 s45, s27, 0
    s_lshl_b32 s34, s29, 13
    s_lshr_b32 s35, s30, 3
    s_lshl_b32 s35, s35, 12
    s_add_u32 s34, s34, s35
    s_add_u32 s46, s34, 0x1000
    s_add_u32 s46, s26, s46
    s_addc_u32 s47, s27, 0
    s_and_b32 s35, s28, 3
    s_mul_i32 s35, s35, 288
    s_movk_i32 s34, 1152
    v_mul_lo_u32 v16, v10, s34
    v_lshl_add_u32 v16, v3, 4, v16
    v_add_u32 v16, s35, v16
    v_add_u32 v20, 20480, v12
    v_add_u32 v21, 20480, v13
    v_add_u32 v22, 20480, v14
    v_add_u32 v23, 20480, v15
    s_waitcnt vmcnt(14)
    ds_read_b128 v[24:27], v16 offset:2048
    ds_read_b64_tr_b16 v[64:65], v20 offset:0
    ds_read_b64_tr_b16 v[66:67], v20 offset:512
    ds_read_b64_tr_b16 v[68:69], v21 offset:0
    ds_read_b64_tr_b16 v[70:71], v21 offset:512
    ds_read_b64_tr_b16 v[72:73], v22 offset:0
    ds_read_b64_tr_b16 v[74:75], v22 offset:512
    ds_read_b64_tr_b16 v[76:77], v23 offset:0
    ds_read_b64_tr_b16 v[78:79], v23 offset:512
    s_waitcnt vmcnt(10)
    ds_read_b128 v[28:31], v16 offset:2112
    ds_read_b64_tr_b16 v[80:81], v20 offset:4096
    ds_read_b64_tr_b16 v[82:83], v20 offset:4608
    ds_read_b64_tr_b16 v[84:85], v21 offset:4096
    ds_read_b64_tr_b16 v[86:87], v21 offset:4608
    s_waitcnt lgkmcnt(11)
    v_mfma_f32_16x16x32_bf16 v[32:35], v[24:27], v[64:67], 0
    ds_read_b64_tr_b16 v[88:89], v22 offset:4096
    ds_read_b64_tr_b16 v[90:91], v22 offset:4608
    s_waitcnt lgkmcnt(11)
    v_mfma_f32_16x16x32_bf16 v[36:39], v[24:27], v[68:71], 0
    ds_read_b64_tr_b16 v[64:65], v23 offset:4096
    ds_read_b64_tr_b16 v[66:67], v23 offset:4608
    s_waitcnt lgkmcnt(11)
    v_mfma_f32_16x16x32_bf16 v[40:43], v[24:27], v[72:75], 0
    s_waitcnt vmcnt(6)
    ds_read_b128 v[100:103], v16 offset:2176
    ds_read_b64_tr_b16 v[68:69], v20 offset:8192
    ds_read_b64_tr_b16 v[70:71], v20 offset:8704
    s_waitcnt lgkmcnt(12)
    v_mfma_f32_16x16x32_bf16 v[44:47], v[24:27], v[76:79], 0
    ds_read_b64_tr_b16 v[72:73], v21 offset:8192
    ds_read_b64_tr_b16 v[74:75], v21 offset:8704
    s_waitcnt lgkmcnt(11)
    v_mfma_f32_16x16x32_bf16 v[32:35], v[28:31], v[80:83], v[32:35]
    ds_read_b64_tr_b16 v[76:77], v22 offset:8192
    ds_read_b64_tr_b16 v[78:79], v22 offset:8704
    s_waitcnt lgkmcnt(11)
    v_mfma_f32_16x16x32_bf16 v[36:39], v[28:31], v[84:87], v[36:39]
    ds_read_b64_tr_b16 v[80:81], v23 offset:8192
    ds_read_b64_tr_b16 v[82:83], v23 offset:8704
    s_waitcnt lgkmcnt(11)
    v_mfma_f32_16x16x32_bf16 v[40:43], v[28:31], v[88:91], v[40:43]
    s_waitcnt vmcnt(2)
    ds_read_b128 v[24:27], v16 offset:2240
    ds_read_b64_tr_b16 v[84:85], v20 offset:12288
    ds_read_b64_tr_b16 v[86:87], v20 offset:12800
    s_waitcnt lgkmcnt(12)
    v_mfma_f32_16x16x32_bf16 v[44:47], v[28:31], v[64:67], v[44:47]
    ds_read_b64_tr_b16 v[88:89], v21 offset:12288
    ds_read_b64_tr_b16 v[90:91], v21 offset:12800
    s_waitcnt lgkmcnt(11)
    v_mfma_f32_16x16x32_bf16 v[32:35], v[100:103], v[68:71], v[32:35]
    ds_read_b64_tr_b16 v[64:65], v22 offset:12288
    ds_read_b64_tr_b16 v[66:67], v22 offset:12800
    s_waitcnt lgkmcnt(11)
    v_mfma_f32_16x16x32_bf16 v[36:39], v[100:103], v[72:75], v[36:39]
    ds_read_b64_tr_b16 v[68:69], v23 offset:12288
    ds_read_b64_tr_b16 v[70:71], v23 offset:12800
    s_waitcnt lgkmcnt(11)
    v_mfma_f32_16x16x32_bf16 v[40:43], v[100:103], v[76:79], v[40:43]
    s_waitcnt vmcnt(0)
    ds_read_b128 v[28:31], v16 offset:2304
    ds_read_b64_tr_b16 v[72:73], v20 offset:16384
    ds_read_b64_tr_b16 v[74:75], v20 offset:16896
    s_waitcnt lgkmcnt(12)
    v_mfma_f32_16x16x32_bf16 v[44:47], v[100:103], v[80:83], v[44:47]
    ds_read_b64_tr_b16 v[76:77], v21 offset:16384
    ds_read_b64_tr_b16 v[78:79], v21 offset:16896
    s_waitcnt lgkmcnt(11)
    v_mfma_f32_16x16x32_bf16 v[32:35], v[24:27], v[84:87], v[32:35]
    ds_read_b64_tr_b16 v[80:81], v22 offset:16384
    ds_read_b64_tr_b16 v[82:83], v22 offset:16896
    s_waitcnt lgkmcnt(11)
    v_mfma_f32_16x16x32_bf16 v[36:39], v[24:27], v[88:91], v[36:39]
    ds_read_b64_tr_b16 v[84:85], v23 offset:16384
    ds_read_b64_tr_b16 v[86:87], v23 offset:16896
    s_waitcnt lgkmcnt(11)
    v_mfma_f32_16x16x32_bf16 v[40:43], v[24:27], v[64:67], v[40:43]
    s_waitcnt lgkmcnt(9)
    v_mfma_f32_16x16x32_bf16 v[44:47], v[24:27], v[68:71], v[44:47]
    s_waitcnt lgkmcnt(6)
    v_mfma_f32_16x16x32_bf16 v[32:35], v[28:31], v[72:75], v[32:35]
    s_waitcnt lgkmcnt(4)
    v_mfma_f32_16x16x32_bf16 v[36:39], v[28:31], v[76:79], v[36:39]
    s_waitcnt lgkmcnt(2)
    v_mfma_f32_16x16x32_bf16 v[40:43], v[28:31], v[80:83], v[40:43]
    s_waitcnt lgkmcnt(0)
    v_mfma_f32_16x16x32_bf16 v[44:47], v[28:31], v[84:87], v[44:47]
    v_mov_b32 v2, 1
    ds_write_b32 v1, v2 offset:88
    s_getreg_b32 s54, hwreg(HW_REG_XCC_ID, 0, 3)
    s_lshl_b32 s54, s54, 8
    s_or_b32 s34, s54, s57
    v_mov_b32 v28, s34
    s_mov_b32 s55, 0xfffff800
    v_bfi_b32 v24, s55, v32, v28
    v_bfi_b32 v25, s58, v36, v58
    v_bfi_b32 v26, s58, v40, v59
    v_bfi_b32 v27, s58, v44, v60
    s_mov_b32 exec_hi, 0
    v_add_u32 v18, 0x200000, v17
    global_store_dwordx4 v18, v[24:27], s[44:45]
    v_mov_b32 v29, v17
    s_mov_b64 exec, -1
    s_bfe_u32 s36, s28, 0x20003
    s_mov_b32 s60, 0x12080200
    s_mov_b32 s61, 0x86590650
    s_mov_b32 s62, 0x89670962
    s_mov_b32 s63, 0xeb60eac
    s_cmp_eq_u32 s36, 1
    s_cselect_b32 s60, 0x12080200, s60
    s_cselect_b32 s61, 0x26591650, s61
    s_cselect_b32 s62, 0x29671962, s62
    s_cselect_b32 s63, 0xeb60eac, s63
    s_cmp_eq_u32 s36, 2
    s_cselect_b32 s60, 0x12080200, s60
    s_cselect_b32 s61, 0x46593650, s61
    s_cselect_b32 s62, 0x69e859a2, s62
    s_cselect_b32 s63, 0xeb679ef, s63
    s_cmp_eq_u32 s36, 3
    s_cselect_b32 s60, 0x12080200, s60
    s_cselect_b32 s61, 0x66595650, s61
    s_cselect_b32 s62, 0x396b7662, s62
    s_cselect_b32 s63, 0xeb649b0, s63
    s_bitcmp1_b32 s28, 2
    s_cselect_b64 s[60:61], s[62:63], s[60:61]
    s_and_b32 s34, s28, 3
    s_lshl_b32 s34, s34, 4
    s_lshr_b64 s[60:61], s[60:61], s34
    s_and_b32 s38, s60, 63
    s_bfe_u32 s39, s60, 0x40006
    s_bfe_u32 s31, s60, 0x2000a
    s_bfe_u32 s35, s60, 0x4000c
    s_lshr_b32 s37, s28, 5
    s_mul_i32 s36, s37, 9
    s_add_u32 s32, s36, s35
    s_sub_u32 s34, s35, s37
    s_add_u32 s34, s34, 3
    s_and_b32 s34, s34, 7
    s_cmp_eq_u32 s35, 8
    s_cselect_b32 s34, 8, s34
    s_add_u32 s33, s36, s34
    s_add_u32 s34, s33, 64
    s_cmp_eq_u32 s31, 1
    s_cselect_b32 s32, s33, s32
    s_cselect_b32 s33, s34, s33
    s_lshr_b32 s34, s28, 3
    s_lshl_b32 s34, s34, 1
    s_add_u32 s34, s34, s35
    s_cmp_eq_u32 s31, 0
    s_cselect_b32 s32, s34, s32
    s_cselect_b32 s33, s34, s33
    v_lshlrev_b32 v16, 4, v0
    v_and_b32 v17, 15, v0
    v_lshlrev_b32 v17, 1, v17
    v_lshl_add_u32 v17, v3, 7, v17
    s_mov_b32 s59, 0
    v_mov_b32 v56, v16
L_pollQ_1:
    s_and_b32 s34, s59, 15
    s_cmp_eq_u32 s34, 15
    s_cselect_b32 s34, 0, 0x200000
    v_add_u32 v16, s34, v56
    global_load_dwordx4 v[64:67], v16, s[46:47] offset:0 sc1
    global_load_dwordx4 v[68:71], v16, s[46:47] offset:1024 sc1
    global_load_dwordx4 v[72:75], v16, s[46:47] offset:2048 sc1
    global_load_dwordx4 v[76:79], v16, s[46:47] offset:3072 sc1
    s_waitcnt vmcnt(0)
    v_xor_b32 v64, s57, v64
    v_xor_b32 v65, s17, v65
    v_xor_b32 v66, s18, v66
    v_xor_b32 v67, s19, v67
    v_xor_b32 v68, s57, v68
    v_xor_b32 v69, s17, v69
    v_xor_b32 v70, s18, v70
    v_xor_b32 v71, s19, v71
    v_xor_b32 v72, s57, v72
    v_xor_b32 v73, s17, v73
    v_xor_b32 v74, s18, v74
    v_xor_b32 v75, s19, v75
    v_xor_b32 v76, s57, v76
    v_xor_b32 v77, s17, v77
    v_xor_b32 v78, s18, v78
    v_xor_b32 v79, s19, v79
    v_or3_b32 v18, v64, v65, v66
    v_or3_b32 v18, v18, v67, v68
    v_or3_b32 v18, v18, v69, v70
    v_or3_b32 v18, v18, v71, v72
    v_or3_b32 v18, v18, v73, v74
    v_or3_b32 v18, v18, v75, v76
    v_or3_b32 v18, v18, v77, v78
    v_or_b32 v18, v18, v79
    v_and_b32 v18, 0xff, v18
    v_cmp_ne_u32 vcc, 0, v18
    s_cbranch_vccz L_polledQ_2
    s_add_u32 s59, s59, 1
    s_cmp_lt_u32 s59, 0x10000
    s_cbranch_scc0 L_polledQ_2
    s_cmp_lg_u32 s59, 3
    s_cbranch_scc1 L_pollQ_1
    s_mov_b32 exec_hi, 0
    global_store_dwordx4 v29, v[24:27], s[44:45] sc1
    s_mov_b64 exec, -1
    s_branch L_pollQ_1
L_polledQ_2:
    v_xor_b32 v80, s54, v64
    v_xor_b32 v81, s54, v68
    v_xor_b32 v82, s54, v72
    v_xor_b32 v83, s54, v76
    v_or3_b32 v80, v80, v81, v82
    v_or_b32 v80, v80, v83
    v_and_b32 v80, 0x700, v80
    v_cmp_ne_u32 vcc, 0, v80
    v_and_b32 v64, s55, v64
    v_and_b32 v68, s55, v68
    v_and_b32 v72, s55, v72
    v_and_b32 v76, s55, v76
    s_cbranch_vccz L_q_same
    s_mov_b32 exec_hi, 0
    global_store_dwordx4 v29, v[24:27], s[44:45] sc1
    s_mov_b64 exec, -1
    s_branch L_q_diff
L_q_same:
    v_mov_b32 v2, 1
    ds_write_b32 v1, v2 offset:96
L_q_diff:
    v_add_f32 v64, v64, v68
    v_add_f32 v72, v72, v76
    v_add_f32 v65, v65, v69
    v_add_f32 v73, v73, v77
    v_add_f32 v66, v66, v70
    v_add_f32 v74, v74, v78
    v_add_f32 v67, v67, v71
    v_add_f32 v75, v75, v79
    v_add_f32 v64, v64, v72
    v_add_f32 v65, v65, v73
    v_add_f32 v66, v66, v74
    v_add_f32 v67, v67, v75
    v_cvt_pk_bf16_f32 v64, v64, v65
    v_cvt_pk_bf16_f32 v65, v66, v67
    ds_write_b16 v17, v64 offset:256
    ds_write_b16_d16_hi v17, v64 offset:288
    ds_write_b16 v17, v65 offset:320
    ds_write_b16_d16_hi v17, v65 offset:352
    v_mov_b32 v2, 1
    ds_write_b32 v1, v2 offset:0
    s_cmp_ge_u32 s31, 2
    s_cbranch_scc1 L_rpath
    s_cmp_eq_u32 s31, 0
    s_cbranch_scc1 L_q_o
    s_lshl_b32 s34, s32, 9
    s_add_u32 s60, s34, 0x40000
    s_add_u32 s60, s26, s60
    s_addc_u32 s61, s27, 0
    v_and_b32 v16, 31, v0
    v_lshlrev_b32 v16, 4, v16
    v_add_u32 v22, 0x200000, v16
    global_load_dwordx4 v[64:67], v22, s[60:61] sc1
L_spin_3:
    ds_read_b32 v2, v1 offset:80
    s_waitcnt lgkmcnt(0)
    v_readfirstlane_b32 s34, v2
    s_cmp_eq_u32 s34, 8
    s_cbranch_scc1 L_spun_4
    s_sleep 2
    s_branch L_spin_3
L_spun_4:
    s_mov_b32 s59, 0
    v_mov_b32 v56, v16
L_pollH_5:
    s_and_b32 s34, s59, 15
    s_cmp_eq_u32 s34, 15
    s_cselect_b32 s34, 0, 0x200000
    v_add_u32 v16, s34, v56
    global_load_dwordx4 v[64:67], v16, s[60:61] sc1
    s_waitcnt vmcnt(0)
    v_xor_b32 v64, s57, v64
    v_xor_b32 v65, s17, v65
    v_xor_b32 v66, s18, v66
    v_xor_b32 v67, s19, v67
    v_or3_b32 v18, v64, v65, v66
    v_or_b32 v18, v18, v67
    v_and_b32 v18, 0xff, v18
    v_cmp_ne_u32 vcc, 0, v18
    s_cbranch_vccz L_polledH_6
    s_add_u32 s59, s59, 1
    s_cmp_lt_u32 s59, 0x10000
    s_cbranch_scc0 L_polledH_6
    s_sleep 2
    s_branch L_pollH_5
L_polledH_6:
    v_cvt_pk_bf16_f32 v64, v64, v65
    v_cvt_pk_bf16_f32 v65, v66, v67
    v_mov_b32 v2, 1
    s_mov_b32 exec_hi, 0
    ds_write_b16 v17, v64 offset:768
    ds_write_b16_d16_hi v17, v64 offset:800
    ds_write_b16 v17, v65 offset:832
    ds_write_b16_d16_hi v17, v65 offset:864
    s_mov_b64 exec, 1
    ds_add_u32 v1, v2 offset:4
    s_mov_b64 exec, -1
    s_branch L_fin
L_q_o:
    s_lshl_b32 s34, s32, 12
    s_add_u32 s60, s34, 0x80000
    s_add_u32 s60, s26, s60
    s_addc_u32 s61, s27, 0
    s_lshr_b32 s34, s32, 1
    s_lshl_b32 s34, s34, 7
    s_add_u32 s62, s34, 0xc8000
    s_add_u32 s62, s26, s62
    s_addc_u32 s63, s27, 0
    v_lshrrev_b32 v18, 5, v0
    v_and_b32 v19, 1, v3
    v_lshlrev_b32 v16, 11, v18
    v_lshl_add_u32 v16, v19, 8, v16
    v_and_b32 v20, 15, v0
    v_lshl_add_u32 v16, v20, 4, v16
    v_lshlrev_b32 v17, 6, v18
    v_lshl_add_u32 v17, v19, 3, v17
    v_lshlrev_b32 v21, 7, v18
    v_bfe_u32 v19, v0, 3, 1
    v_lshl_add_u32 v21, v19, 6, v21
    v_and_b32 v19, 7, v0
    v_lshl_add_u32 v21, v19, 1, v21
    v_and_b32 v19, 1, v3
    v_lshl_add_u32 v21, v19, 4, v21
    v_add_u32 v22, 0x200000, v16
    v_add_u32 v23, 0x200000, v17
    global_load_dwordx2 v[112:113], v23, s[62:63] sc1
    global_load_dwordx4 v[96:99], v22, s[60:61] offset:0 sc1
    global_load_dwordx4 v[100:103], v22, s[60:61] offset:512 sc1
    global_load_dwordx4 v[104:107], v22, s[60:61] offset:1024 sc1
    global_load_dwordx4 v[108:111], v22, s[60:61] offset:1536 sc1
L_spin_7:
    ds_read_b32 v2, v1 offset:64
    s_waitcnt lgkmcnt(0)
    v_readfirstlane_b32 s34, v2
    s_cmp_eq_u32 s34, 8
    s_cbranch_scc1 L_spun_8
    s_sleep 2
    s_branch L_spin_7
L_spun_8:
    s_mov_b32 s59, 0
    v_mov_b32 v56, v16
    v_mov_b32 v57, v17
L_pollO_9:
    s_and_b32 s34, s59, 15
    s_cmp_eq_u32 s34, 15
    s_cselect_b32 s34, 0, 0x200000
    v_add_u32 v16, s34, v56
    v_add_u32 v17, s34, v57
    global_load_dwordx2 v[112:113], v17, s[62:63] offset:0 sc1
    global_load_dwordx2 v[116:117], v17, s[62:63] offset:16 sc1
    global_load_dwordx2 v[120:121], v17, s[62:63] offset:32 sc1
    global_load_dwordx2 v[124:125], v17, s[62:63] offset:48 sc1
    global_load_dwordx4 v[96:99], v16, s[60:61] offset:0 sc1
    global_load_dwordx4 v[100:103], v16, s[60:61] offset:512 sc1
    global_load_dwordx4 v[104:107], v16, s[60:61] offset:1024 sc1
    global_load_dwordx4 v[108:111], v16, s[60:61] offset:1536 sc1
    s_waitcnt vmcnt(0)
    v_xor_b32 v112, s57, v112
    v_xor_b32 v113, s17, v113
    v_xor_b32 v116, s57, v116
    v_xor_b32 v117, s17, v117
    v_xor_b32 v120, s57, v120
    v_xor_b32 v121, s17, v121
    v_xor_b32 v124, s57, v124
    v_xor_b32 v125, s17, v125
    v_xor_b32 v96, s57, v96
    v_xor_b32 v97, s17, v97
    v_xor_b32 v98, s18, v98
    v_xor_b32 v99, s19, v99
    v_xor_b32 v100, s57, v100
    v_xor_b32 v101, s17, v101
    v_xor_b32 v102, s18, v102
    v_xor_b32 v103, s19, v103
    v_xor_b32 v104, s57, v104
    v_xor_b32 v105, s17, v105
    v_xor_b32 v106, s18, v106
    v_xor_b32 v107, s19, v107
    v_xor_b32 v108, s57, v108
    v_xor_b32 v109, s17, v109
    v_xor_b32 v110, s18, v110
    v_xor_b32 v111, s19, v111
    v_or3_b32 v18, v112, v113, v116
    v_or3_b32 v18, v18, v117, v120
    v_or3_b32 v18, v18, v121, v124
    v_or3_b32 v18, v18, v125, v96
    v_or3_b32 v18, v18, v97, v98
    v_or3_b32 v18, v18, v99, v100
    v_or3_b32 v18, v18, v101, v102
    v_or3_b32 v18, v18, v103, v104
    v_or3_b32 v18, v18, v105, v106
    v_or3_b32 v18, v18, v107, v108
    v_or3_b32 v18, v18, v109, v110
    v_or_b32 v18, v18, v111
    v_and_b32 v18, 0xff, v18
    v_cmp_ne_u32 vcc, 0, v18
    s_cbranch_vccz L_polledO_10
    s_add_u32 s59, s59, 1
    s_cmp_lt_u32 s59, 0x10000
    s_cbranch_scc0 L_polledO_10
    s_branch L_pollO_9
L_polledO_10:
    v_max3_f32 v24, v112, v116, v120
    v_max_f32 v24, v24, v124
    v_mov_b32 v25, v24
    s_nop 1
    v_permlane16_swap_b32 v24, v25
    v_max_f32 v24, v24, v25
    v_sub_f32 v112, v112, v24
    v_sub_f32 v116, v116, v24
    v_sub_f32 v120, v120, v24
    v_sub_f32 v124, v124, v24
    v_exp_f32 v112, v112
    v_exp_f32 v116, v116
    v_exp_f32 v120, v120
    v_exp_f32 v124, v124
    s_nop 0
    v_mul_f32 v28, v112, v113
    v_fmac_f32 v28, v116, v117
    v_fmac_f32 v28, v120, v121
    v_fmac_f32 v28, v124, v125
    v_mul_f32 v24, v112, v96
    v_mul_f32 v25, v112, v97
    v_mul_f32 v26, v112, v98
    v_mul_f32 v27, v112, v99
    v_fmac_f32 v24, v116, v100
    v_fmac_f32 v25, v116, v101
    v_fmac_f32 v26, v116, v102
    v_fmac_f32 v27, v116, v103
    v_fmac_f32 v24, v120, v104
    v_fmac_f32 v25, v120, v105
    v_fmac_f32 v26, v120, v106
    v_fmac_f32 v27, v120, v107
    v_fmac_f32 v24, v124, v108
    v_fmac_f32 v25, v124, v109
    v_fmac_f32 v26, v124, v110
    v_fmac_f32 v27, v124, v111
    v_mov_b32 v36, v28
    v_mov_b32 v2, 1
    v_permlane16_swap_b32 v24, v25
    v_permlane16_swap_b32 v26, v27
    v_permlane16_swap_b32 v28, v36
    v_add_f32 v28, v28, v36
    v_rcp_f32 v28, v28
    v_add_f32 v24, v24, v25
    v_add_f32 v26, v26, v27
    v_mul_f32 v24, v24, v28
    v_mul_f32 v26, v26, v28
    v_cvt_pk_bf16_f32 v24, v24, v26
    ds_write_b16 v21, v24 offset:768
    ds_write_b16_d16_hi v21, v24 offset:800
    s_mov_b64 exec, 1
    ds_add_u32 v1, v2 offset:4
    s_mov_b64 exec, -1
    s_branch L_fin
L_att:
    s_load_dwordx2 s[40:41], s[0:1], 8
    s_load_dwordx2 s[4:5], s[0:1], 16
    s_lshr_b32 s29, s28, 4
    s_and_b32 s30, s28, 15
    s_bfe_u32 s36, s28, 0x20003
    s_mov_b32 s60, 0x12080200
    s_mov_b32 s61, 0x86590650
    s_mov_b32 s62, 0x89670962
    s_mov_b32 s63, 0xeb60eac
    s_cmp_eq_u32 s36, 1
    s_cselect_b32 s60, 0x12080200, s60
    s_cselect_b32 s61, 0x26591650, s61
    s_cselect_b32 s62, 0x29671962, s62
    s_cselect_b32 s63, 0xeb60eac, s63
    s_cmp_eq_u32 s36, 2
    s_cselect_b32 s60, 0x12080200, s60
    s_cselect_b32 s61, 0x46593650, s61
    s_cselect_b32 s62, 0x69e859a2, s62
    s_cselect_b32 s63, 0xeb679ef, s63
    s_cmp_eq_u32 s36, 3
    s_cselect_b32 s60, 0x12080200, s60
    s_cselect_b32 s61, 0x66595650, s61
    s_cselect_b32 s62, 0x396b7662, s62
    s_cselect_b32 s63, 0xeb649b0, s63
    s_bitcmp1_b32 s28, 2
    s_cselect_b64 s[60:61], s[62:63], s[60:61]
    s_and_b32 s34, s28, 3
    s_lshl_b32 s34, s34, 4
    s_lshr_b64 s[60:61], s[60:61], s34
    s_and_b32 s38, s60, 63
    s_bfe_u32 s39, s60, 0x40006
    s_bfe_u32 s31, s60, 0x2000a
    s_bfe_u32 s35, s60, 0x4000c
    s_sub_u32 s3, s3, 1
    v_bfe_u32 v16, v0, 2, 2
    v_lshlrev_b32 v16, 8, v16
    v_lshl_add_u32 v16, v3, 6, v16
    v_and_b32 v17, 3, v0
    v_lshl_add_u32 v16, v17, 4, v16
    v_lshlrev_b32 v17, 4, v0
    s_lshr_b32 s34, s30, 3
    s_lshl_b32 s34, s34, 4
    s_add_u32 s34, s34, s29
    s_lshl_b32 s34, s34, 21
    s_add_u32 s34, s34, 1572864
    s_lshl_b32 s38, s38, 13
    s_add_u32 s34, s34, s38
    s_mul_i32 s38, s3, s39
    s_lshl_b32 s38, s38, 10
    s_add_u32 s46, s34, s38
    s_lshl_b32 s34, s39, 10
    s_add_u32 s45, s46, s34
    s_add_u32 s37, s28, s3
    s_and_b32 s37, s37, 7
    s_sub_u32 s34, s37, s39
    s_cselect_b32 s37, s37, s34
    s_lshl_b32 s37, s37, 10
    s_add_u32 s44, s46, s37
    s_mov_b32 s42, 0x4000000
    s_mov_b32 s43, 0x20000
    s_mov_b32 s6, 0x4000000
    s_mov_b32 s7, 0x20000
    s_setprio 1
    s_waitcnt lgkmcnt(0)
    s_load_dword s56, s[26:27], 0
    s_barrier
    s_cmp_eq_u32 s39, 5
    s_cbranch_scc1 L_kv5
    s_cmp_eq_u32 s39, 6
    s_cbranch_scc1 L_kv4
    s_cmp_eq_u32 s39, 7
    s_cbranch_scc1 L_kv3
    s_cmp_eq_u32 s39, 8
    s_cbranch_scc1 L_kv2
    s_cmp_eq_u32 s39, 9
    s_cbranch_scc1 L_kv1
    buffer_load_dwordx4 v[68:71], v16, s[40:43], s44 offen nt
    s_add_u32 s44, s44, 1024
    s_cmp_eq_u32 s44, s45
    s_cselect_b32 s44, s46, s44
    buffer_load_dwordx4 v[72:75], v16, s[40:43], s44 offen nt
    s_add_u32 s44, s44, 1024
    s_cmp_eq_u32 s44, s45
    s_cselect_b32 s44, s46, s44
    buffer_load_dwordx4 v[76:79], v16, s[40:43], s44 offen nt
    s_add_u32 s44, s44, 1024
    s_cmp_eq_u32 s44, s45
    s_cselect_b32 s44, s46, s44
    buffer_load_dwordx4 v[80:83], v16, s[40:43], s44 offen nt
    s_add_u32 s44, s44, 1024
    s_cmp_eq_u32 s44, s45
    s_cselect_b32 s44, s46, s44
    buffer_load_dwordx4 v[84:87], v16, s[40:43], s44 offen nt
    s_add_u32 s44, s44, 1024
    s_cmp_eq_u32 s44, s45
    s_cselect_b32 s44, s46, s44
    s_waitcnt vmcnt(4)
    buffer_load_dwordx4 v[88:91], v16, s[40:43], s44 offen nt
    s_add_u32 s44, s44, 1024
    s_cmp_eq_u32 s44, s45
    s_cselect_b32 s44, s46, s44
    s_waitcnt vmcnt(4)
    buffer_load_dwordx4 v[92:95], v16, s[40:43], s44 offen nt
    s_add_u32 s44, s44, 1024
    s_cmp_eq_u32 s44, s45
    s_cselect_b32 s44, s46, s44
    s_waitcnt vmcnt(4)
    buffer_load_dwordx4 v[96:99], v16, s[40:43], s44 offen nt
    s_add_u32 s44, s44, 1024
    s_cmp_eq_u32 s44, s45
    s_cselect_b32 s44, s46, s44
    s_waitcnt vmcnt(4)
    buffer_load_dwordx4 v[100:103], v16, s[40:43], s44 offen nt
    s_add_u32 s44, s44, 1024
    s_cmp_eq_u32 s44, s45
    s_cselect_b32 s44, s46, s44
    s_waitcnt vmcnt(4)
    buffer_load_dwordx4 v[104:107], v16, s[40:43], s44 offen nt
    s_add_u32 s44, s44, 1024
    s_cmp_eq_u32 s44, s45
    s_cselect_b32 s44, s46, s44
    s_waitcnt vmcnt(4)
    buffer_load_dwordx4 v[108:111], v17, s[4:7], s44 offen nt
    s_add_u32 s44, s44, 1024
    s_cmp_eq_u32 s44, s45
    s_cselect_b32 s44, s46, s44
    s_waitcnt vmcnt(5)
    buffer_load_dwordx4 v[112:115], v17, s[4:7], s44 offen nt
    s_add_u32 s44, s44, 1024
    s_cmp_eq_u32 s44, s45
    s_cselect_b32 s44, s46, s44
    s_waitcnt vmcnt(5)
    buffer_load_dwordx4 v[116:119], v17, s[4:7], s44 offen nt
    s_add_u32 s44, s44, 1024
    s_cmp_eq_u32 s44, s45
    s_cselect_b32 s44, s46, s44
    s_waitcnt vmcnt(5)
    buffer_load_dwordx4 v[120:123], v17, s[4:7], s44 offen nt
    s_add_u32 s44, s44, 1024
    s_cmp_eq_u32 s44, s45
    s_cselect_b32 s44, s46, s44
    s_waitcnt vmcnt(5)
    buffer_load_dwordx4 v[124:127], v17, s[4:7], s44 offen nt
    s_add_u32 s44, s44, 1024
    s_cmp_eq_u32 s44, s45
    s_cselect_b32 s44, s46, s44
    s_waitcnt vmcnt(5)
    buffer_load_dwordx4 v[128:131], v17, s[4:7], s44 offen nt
    s_add_u32 s44, s44, 1024
    s_cmp_eq_u32 s44, s45
    s_cselect_b32 s44, s46, s44
    s_waitcnt vmcnt(5)
    buffer_load_dwordx4 v[132:135], v17, s[4:7], s44 offen nt
    s_add_u32 s44, s44, 1024
    s_cmp_eq_u32 s44, s45
    s_cselect_b32 s44, s46, s44
    s_waitcnt vmcnt(5)
    buffer_load_dwordx4 v[136:139], v17, s[4:7], s44 offen nt
    s_add_u32 s44, s44, 1024
    s_cmp_eq_u32 s44, s45
    s_cselect_b32 s44, s46, s44
    s_waitcnt vmcnt(5)
    buffer_load_dwordx4 v[140:143], v17, s[4:7], s44 offen nt
    s_add_u32 s44, s44, 1024
    s_cmp_eq_u32 s44, s45
    s_cselect_b32 s44, s46, s44
    s_waitcnt vmcnt(5)
    buffer_load_dwordx4 v[144:147], v17, s[4:7], s44 offen nt
    s_branch L_kvdone
L_kv1:
    buffer_load_dwordx4 v[72:75], v16, s[40:43], s44 offen nt
    s_add_u32 s44, s44, 1024
    s_cmp_eq_u32 s44, s45
    s_cselect_b32 s44, s46, s44
L_kv2:
    buffer_load_dwordx4 v[76:79], v16, s[40:43], s44 offen nt
    s_add_u32 s44, s44, 1024
    s_cmp_eq_u32 s44, s45
    s_cselect_b32 s44, s46, s44
L_kv3:
    buffer_load_dwordx4 v[80:83], v16, s[40:43], s44 offen nt
    s_add_u32 s44, s44, 1024
    s_cmp_eq_u32 s44, s45
    s_cselect_b32 s44, s46, s44
L_kv4:
    buffer_load_dwordx4 v[84:87], v16, s[40:43], s44 offen nt
    s_add_u32 s44, s44, 1024
    s_cmp_eq_u32 s44, s45
    s_cselect_b32 s44, s46, s44
L_kv5:
    s_waitcnt vmcnt(4)
    buffer_load_dwordx4 v[88:91], v16, s[40:43], s44 offen nt
    s_add_u32 s44, s44, 1024
    s_cmp_eq_u32 s44, s45
    s_cselect_b32 s44, s46, s44
    s_waitcnt vmcnt(4)
    buffer_load_dwordx4 v[92:95], v16, s[40:43], s44 offen nt
    s_add_u32 s44, s44, 1024
    s_cmp_eq_u32 s44, s45
    s_cselect_b32 s44, s46, s44
    s_waitcnt vmcnt(4)
    buffer_load_dwordx4 v[96:99], v16, s[40:43], s44 offen nt
    s_add_u32 s44, s44, 1024
    s_cmp_eq_u32 s44, s45
    s_cselect_b32 s44, s46, s44
    s_waitcnt vmcnt(4)
    buffer_load_dwordx4 v[100:103], v16, s[40:43], s44 offen nt
    s_add_u32 s44, s44, 1024
    s_cmp_eq_u32 s44, s45
    s_cselect_b32 s44, s46, s44
    s_waitcnt vmcnt(4)
    buffer_load_dwordx4 v[104:107], v16, s[40:43], s44 offen nt
    s_add_u32 s44, s44, 1024
    s_cmp_eq_u32 s44, s45
    s_cselect_b32 s44, s46, s44
    s_cmp_eq_u32 s39, 5
    s_cbranch_scc1 L_kv15
    s_cmp_eq_u32 s39, 6
    s_cbranch_scc1 L_kv14
    s_cmp_eq_u32 s39, 7
    s_cbranch_scc1 L_kv13
    s_cmp_eq_u32 s39, 8
    s_cbranch_scc1 L_kv12
    s_cmp_eq_u32 s39, 9
    s_cbranch_scc1 L_kv11
L_kv11:
    s_waitcnt vmcnt(3)
    buffer_load_dwordx4 v[112:115], v17, s[4:7], s44 offen nt
    s_add_u32 s44, s44, 1024
    s_cmp_eq_u32 s44, s45
    s_cselect_b32 s44, s46, s44
L_kv12:
    s_waitcnt vmcnt(3)
    buffer_load_dwordx4 v[116:119], v17, s[4:7], s44 offen nt
    s_add_u32 s44, s44, 1024
    s_cmp_eq_u32 s44, s45
    s_cselect_b32 s44, s46, s44
L_kv13:
    s_waitcnt vmcnt(3)
    buffer_load_dwordx4 v[120:123], v17, s[4:7], s44 offen nt
    s_add_u32 s44, s44, 1024
    s_cmp_eq_u32 s44, s45
    s_cselect_b32 s44, s46, s44
L_kv14:
    s_waitcnt vmcnt(3)
    buffer_load_dwordx4 v[124:127], v17, s[4:7], s44 offen nt
    s_add_u32 s44, s44, 1024
    s_cmp_eq_u32 s44, s45
    s_cselect_b32 s44, s46, s44
L_kv15:
    s_waitcnt vmcnt(3)
    buffer_load_dwordx4 v[128:131], v17, s[4:7], s44 offen nt
    s_add_u32 s44, s44, 1024
    s_cmp_eq_u32 s44, s45
    s_cselect_b32 s44, s46, s44
    s_waitcnt vmcnt(3)
    buffer_load_dwordx4 v[132:135], v17, s[4:7], s44 offen nt
    s_add_u32 s44, s44, 1024
    s_cmp_eq_u32 s44, s45
    s_cselect_b32 s44, s46, s44
    s_waitcnt vmcnt(3)
    buffer_load_dwordx4 v[136:139], v17, s[4:7], s44 offen nt
    s_add_u32 s44, s44, 1024
    s_cmp_eq_u32 s44, s45
    s_cselect_b32 s44, s46, s44
    s_waitcnt vmcnt(3)
    buffer_load_dwordx4 v[140:143], v17, s[4:7], s44 offen nt
    s_add_u32 s44, s44, 1024
    s_cmp_eq_u32 s44, s45
    s_cselect_b32 s44, s46, s44
    s_waitcnt vmcnt(3)
    buffer_load_dwordx4 v[144:147], v17, s[4:7], s44 offen nt
L_kvdone:
    v_mov_b32 v2, 1
    s_mov_b64 exec, 1
    ds_add_u32 v1, v2 offset:80
    s_mov_b64 exec, -1
    v_bfe_u32 v18, v0, 3, 1
    v_lshlrev_b32 v18, 8, v18
    v_lshl_add_u32 v18, v3, 6, v18
    v_and_b32 v19, 3, v0
    v_lshl_add_u32 v18, v19, 4, v18
    v_and_b32 v19, 1, v0
    v_lshlrev_b32 v19, 4, v19
    v_mov_b32 v24, 0xffff
    v_lshlrev_b32 v24, v19, v24
    v_bfe_u32 v19, v0, 1, 2
    v_cmp_eq_u32 vcc, 0, v19
    s_nop 1
    v_cndmask_b32 v20, 0, v24, vcc
    v_cmp_eq_u32 vcc, 1, v19
    s_nop 1
    v_cndmask_b32 v21, 0, v24, vcc
    v_cmp_eq_u32 vcc, 2, v19
    s_nop 1
    v_cndmask_b32 v22, 0, v24, vcc
    v_cmp_eq_u32 vcc, 3, v19
    s_nop 1
    v_cndmask_b32 v23, 0, v24, vcc
    s_mov_b32 s38, 0x3fb8aa3b
    s_mov_b32 s8, 0x3db504f3
    s_mov_b32 s9, 0xffff0000
    s_cmp_lt_u32 s39, 10
    s_cselect_b32 s10, 0xff800000, 0
    s_cmp_lt_u32 s39, 9
    s_cselect_b32 s11, 0xff800000, 0
    s_cmp_lt_u32 s39, 8
    s_cselect_b32 s12, 0xff800000, 0
    s_cmp_lt_u32 s39, 7
    s_cselect_b32 s13, 0xff800000, 0
    s_cmp_lt_u32 s39, 6
    s_cselect_b32 s14, 0xff800000, 0
    s_cmp_ge_u32 s39, 10
    s_cbranch_scc1 L_zdone
    v_mov_b32 v68, 0
    v_mov_b32 v108, 0
    v_mov_b32 v69, 0
    v_mov_b32 v109, 0
    v_mov_b32 v70, 0
    v_mov_b32 v110, 0
    v_mov_b32 v71, 0
    v_mov_b32 v111, 0
    s_cmp_ge_u32 s39, 9
    s_cbranch_scc1 L_zdone
    v_mov_b32 v72, 0
    v_mov_b32 v112, 0
    v_mov_b32 v73, 0
    v_mov_b32 v113, 0
    v_mov_b32 v74, 0
    v_mov_b32 v114, 0
    v_mov_b32 v75, 0
    v_mov_b32 v115, 0
    s_cmp_ge_u32 s39, 8
    s_cbranch_scc1 L_zdone
    v_mov_b32 v76, 0
    v_mov_b32 v116, 0
    v_mov_b32 v77, 0
    v_mov_b32 v117, 0
    v_mov_b32 v78, 0
    v_mov_b32 v118, 0
    v_mov_b32 v79, 0
    v_mov_b32 v119, 0
    s_cmp_ge_u32 s39, 7
    s_cbranch_scc1 L_zdone
    v_mov_b32 v80, 0
    v_mov_b32 v120, 0
    v_mov_b32 v81, 0
    v_mov_b32 v121, 0
    v_mov_b32 v82, 0
    v_mov_b32 v122, 0
    v_mov_b32 v83, 0
    v_mov_b32 v123, 0
    s_cmp_ge_u32 s39, 6
    s_cbranch_scc1 L_zdone
    v_mov_b32 v84, 0
    v_mov_b32 v124, 0
    v_mov_b32 v85, 0
    v_mov_b32 v125, 0
    v_mov_b32 v86, 0
    v_mov_b32 v126, 0
    v_mov_b32 v87, 0
    v_mov_b32 v127, 0
L_zdone:
    s_waitcnt lgkmcnt(0)
    s_add_u32 s19, s56, 1
    s_and_b32 s57, s19, 0xff
    s_bfe_u32 s17, s19, 0x80008
    s_bfe_u32 s18, s19, 0x80010
    s_lshr_b32 s19, s19, 24
    s_xor_b32 s17, s17, s57
    s_xor_b32 s18, s18, s57
    s_xor_b32 s19, s19, s57
    s_mov_b32 s58, 0xffffff00
    v_mov_b32 v11, s57
    v_mov_b32 v58, s17
    v_mov_b32 v59, s18
    v_mov_b32 v60, s19
L_spin_11:
    ds_read_b32 v2, v1 offset:0
    s_waitcnt lgkmcnt(0)
    v_readfirstlane_b32 s34, v2
    s_cmp_lg_u32 s34, 0
    s_cbranch_scc1 L_spun_12
    s_sleep 1
    s_branch L_spin_11
L_spun_12:
    ds_read_b128 v[24:27], v18 offset:256
    s_waitcnt lgkmcnt(0)
    v_mfma_f32_16x16x32_bf16 v[64:67], v[68:71], v[24:27], 0
    v_mfma_f32_16x16x32_bf16 v[68:71], v[72:75], v[24:27], 0
    v_mfma_f32_16x16x32_bf16 v[72:75], v[76:79], v[24:27], 0
    v_mfma_f32_16x16x32_bf16 v[76:79], v[80:83], v[24:27], 0
    v_mfma_f32_16x16x32_bf16 v[80:83], v[84:87], v[24:27], 0
    v_mfma_f32_16x16x32_bf16 v[84:87], v[88:91], v[24:27], 0
    v_mfma_f32_16x16x32_bf16 v[88:91], v[92:95], v[24:27], 0
    v_mfma_f32_16x16x32_bf16 v[92:95], v[96:99], v[24:27], 0
    v_mfma_f32_16x16x32_bf16 v[96:99], v[100:103], v[24:27], 0
    v_mfma_f32_16x16x32_bf16 v[100:103], v[104:107], v[24:27], 0
    v_mov_b32_dpp v32, v64 quad_perm:[0,0,0,0] row_mask:0xf bank_mask:0xf
    v_mov_b32_dpp v33, v68 quad_perm:[0,0,0,0] row_mask:0xf bank_mask:0xf
    v_mov_b32_dpp v34, v72 quad_perm:[0,0,0,0] row_mask:0xf bank_mask:0xf
    v_mov_b32_dpp v35, v76 quad_perm:[0,0,0,0] row_mask:0xf bank_mask:0xf
    v_mov_b32_dpp v36, v80 quad_perm:[0,0,0,0] row_mask:0xf bank_mask:0xf
    v_mov_b32_dpp v37, v84 quad_perm:[0,0,0,0] row_mask:0xf bank_mask:0xf
    v_mov_b32_dpp v38, v88 quad_perm:[0,0,0,0] row_mask:0xf bank_mask:0xf
    v_mov_b32_dpp v39, v92 quad_perm:[0,0,0,0] row_mask:0xf bank_mask:0xf
    v_mov_b32_dpp v40, v96 quad_perm:[0,0,0,0] row_mask:0xf bank_mask:0xf
    v_mov_b32_dpp v41, v100 quad_perm:[0,0,0,0] row_mask:0xf bank_mask:0xf
    v_add_f32_dpp v32, v65, v32 quad_perm:[1,1,1,1] row_mask:0xf bank_mask:0xf
    v_add_f32_dpp v33, v69, v33 quad_perm:[1,1,1,1] row_mask:0xf bank_mask:0xf
    v_add_f32_dpp v34, v73, v34 quad_perm:[1,1,1,1] row_mask:0xf bank_mask:0xf
    v_add_f32_dpp v35, v77, v35 quad_perm:[1,1,1,1] row_mask:0xf bank_mask:0xf
    v_add_f32_dpp v36, v81, v36 quad_perm:[1,1,1,1] row_mask:0xf bank_mask:0xf
    v_add_f32_dpp v37, v85, v37 quad_perm:[1,1,1,1] row_mask:0xf bank_mask:0xf
    v_add_f32_dpp v38, v89, v38 quad_perm:[1,1,1,1] row_mask:0xf bank_mask:0xf
    v_add_f32_dpp v39, v93, v39 quad_perm:[1,1,1,1] row_mask:0xf bank_mask:0xf
    v_add_f32_dpp v40, v97, v40 quad_perm:[1,1,1,1] row_mask:0xf bank_mask:0xf
    v_add_f32_dpp v41, v101, v41 quad_perm:[1,1,1,1] row_mask:0xf bank_mask:0xf
    v_add_f32_dpp v32, v66, v32 quad_perm:[2,2,2,2] row_mask:0xf bank_mask:0xf
    v_add_f32_dpp v33, v70, v33 quad_perm:[2,2,2,2] row_mask:0xf bank_mask:0xf
    v_add_f32_dpp v34, v74, v34 quad_perm:[2,2,2,2] row_mask:0xf bank_mask:0xf
    v_add_f32_dpp v35, v78, v35 quad_perm:[2,2,2,2] row_mask:0xf bank_mask:0xf
    v_add_f32_dpp v36, v82, v36 quad_perm:[2,2,2,2] row_mask:0xf bank_mask:0xf
    v_add_f32_dpp v37, v86, v37 quad_perm:[2,2,2,2] row_mask:0xf bank_mask:0xf
    v_add_f32_dpp v38, v90, v38 quad_perm:[2,2,2,2] row_mask:0xf bank_mask:0xf
    v_add_f32_dpp v39, v94, v39 quad_perm:[2,2,2,2] row_mask:0xf bank_mask:0xf
    v_add_f32_dpp v40, v98, v40 quad_perm:[2,2,2,2] row_mask:0xf bank_mask:0xf
    v_add_f32_dpp v41, v102, v41 quad_perm:[2,2,2,2] row_mask:0xf bank_mask:0xf
    v_add_f32_dpp v32, v67, v32 quad_perm:[3,3,3,3] row_mask:0xf bank_mask:0xf
    v_add_f32_dpp v33, v71, v33 quad_perm:[3,3,3,3] row_mask:0xf bank_mask:0xf
    v_add_f32_dpp v34, v75, v34 quad_perm:[3,3,3,3] row_mask:0xf bank_mask:0xf
    v_add_f32_dpp v35, v79, v35 quad_perm:[3,3,3,3] row_mask:0xf bank_mask:0xf
    v_add_f32_dpp v36, v83, v36 quad_perm:[3,3,3,3] row_mask:0xf bank_mask:0xf
    v_add_f32_dpp v37, v87, v37 quad_perm:[3,3,3,3] row_mask:0xf bank_mask:0xf
    v_add_f32_dpp v38, v91, v38 quad_perm:[3,3,3,3] row_mask:0xf bank_mask:0xf
    v_add_f32_dpp v39, v95, v39 quad_perm:[3,3,3,3] row_mask:0xf bank_mask:0xf
    v_add_f32_dpp v40, v99, v40 quad_perm:[3,3,3,3] row_mask:0xf bank_mask:0xf
    v_add_f32_dpp v41, v103, v41 quad_perm:[3,3,3,3] row_mask:0xf bank_mask:0xf
    v_cvt_pk_bf16_f32 v42, v32, v33
    v_cvt_pk_bf16_f32 v43, v34, v35
    v_cvt_pk_bf16_f32 v44, v36, v37
    v_cvt_pk_bf16_f32 v45, v38, v39
    v_cvt_pk_bf16_f32 v46, v40, v41
    v_lshlrev_b32 v32, 16, v42
    v_and_b32 v33, s9, v42
    v_lshlrev_b32 v34, 16, v43
    v_and_b32 v35, s9, v43
    v_lshlrev_b32 v36, 16, v44
    v_and_b32 v37, s9, v44
    v_lshlrev_b32 v38, 16, v45
    v_and_b32 v39, s9, v45
    v_lshlrev_b32 v40, 16, v46
    v_and_b32 v41, s9, v46
    v_mul_f32 v32, s8, v32
    v_mul_f32 v33, s8, v33
    v_mul_f32 v34, s8, v34
    v_mul_f32 v35, s8, v35
    v_mul_f32 v36, s8, v36
    v_mul_f32 v37, s8, v37
    v_mul_f32 v38, s8, v38
    v_mul_f32 v39, s8, v39
    v_mul_f32 v40, s8, v40
    v_mul_f32 v41, s8, v41
    v_cvt_pk_bf16_f32 v42, v32, v33
    v_cvt_pk_bf16_f32 v43, v34, v35
    v_cvt_pk_bf16_f32 v44, v36, v37
    v_cvt_pk_bf16_f32 v45, v38, v39
    v_cvt_pk_bf16_f32 v46, v40, v41
    v_lshlrev_b32 v32, 16, v42
    v_and_b32 v33, s9, v42
    v_lshlrev_b32 v34, 16, v43
    v_and_b32 v35, s9, v43
    v_lshlrev_b32 v36, 16, v44
    v_and_b32 v37, s9, v44
    v_lshlrev_b32 v38, 16, v45
    v_and_b32 v39, s9, v45
    v_lshlrev_b32 v40, 16, v46
    v_and_b32 v41, s9, v46
    v_add_f32 v32, s10, v32
    v_add_f32 v33, s11, v33
    v_add_f32 v34, s12, v34
    v_add_f32 v35, s13, v35
    v_add_f32 v36, s14, v36
    v_max3_f32 v28, v32, v33, v34
    v_max3_f32 v29, v35, v36, v37
    v_max3_f32 v28, v28, v38, v39
    v_max3_f32 v29, v29, v40, v41
    v_max_f32 v28, v28, v29
    v_mov_b32 v30, v28
    s_nop 1
    v_permlane16_swap_b32 v28, v30
    v_max_f32 v28, v28, v30
    v_mov_b32 v30, v28
    s_nop 1
    v_permlane32_swap_b32 v28, v30
    v_max_f32 v28, v28, v30
    v_mul_f32 v28, s38, v28
    v_fma_f32 v32, v32, s38, -v28
    v_fma_f32 v33, v33, s38, -v28
    v_fma_f32 v34, v34, s38, -v28
    v_fma_f32 v35, v35, s38, -v28
    v_fma_f32 v36, v36, s38, -v28
    v_fma_f32 v37, v37, s38, -v28
    v_fma_f32 v38, v38, s38, -v28
    v_fma_f32 v39, v39, s38, -v28
    v_fma_f32 v40, v40, s38, -v28
    v_fma_f32 v41, v41, s38, -v28
    v_exp_f32 v32, v32
    v_exp_f32 v33, v33
    v_exp_f32 v34, v34
    v_exp_f32 v35, v35
    v_exp_f32 v36, v36
    v_exp_f32 v37, v37
    v_exp_f32 v38, v38
    v_exp_f32 v39, v39
    v_exp_f32 v40, v40
    v_exp_f32 v41, v41
    s_nop 0
    v_cvt_pk_bf16_f32 v42, v32, v32
    v_cvt_pk_bf16_f32 v43, v33, v33
    v_cvt_pk_bf16_f32 v44, v34, v34
    v_cvt_pk_bf16_f32 v45, v35, v35
    v_cvt_pk_bf16_f32 v46, v36, v36
    v_cvt_pk_bf16_f32 v47, v37, v37
    v_cvt_pk_bf16_f32 v48, v38, v38
    v_cvt_pk_bf16_f32 v49, v39, v39
    v_cvt_pk_bf16_f32 v50, v40, v40
    v_cvt_pk_bf16_f32 v51, v41, v41
    v_add_f32 v29, v32, v33
    v_add_f32 v30, v34, v35
    v_add_f32 v31, v36, v37
    v_add_f32 v29, v29, v38
    v_add_f32 v30, v30, v39
    v_add_f32 v31, v31, v40
    v_add_f32 v29, v29, v41
    v_add_f32 v29, v29, v30
    v_add_f32 v29, v29, v31
    v_mov_b32 v30, v29
    s_nop 1
    v_permlane16_swap_b32 v29, v30
    v_add_f32 v29, v29, v30
    v_mov_b32 v30, v29
    s_nop 1
    v_permlane32_swap_b32 v29, v30
    v_add_f32 v29, v29, v30
    s_lshl_b32 s34, s3, 10
    v_lshl_add_u32 v30, v0, 4, s34
    s_lshl_b32 s34, s3, 9
    v_lshl_add_u32 v31, v0, 3, s34
    ds_write_b64 v31, v[28:29] offset:16384
    v_and_b32 v64, v42, v20
    v_and_b32 v65, v42, v21
    v_and_b32 v66, v42, v22
    v_and_b32 v67, v42, v23
    v_and_b32 v68, v43, v20
    v_and_b32 v69, v43, v21
    v_and_b32 v70, v43, v22
    v_and_b32 v71, v43, v23
    v_mfma_f32_16x16x32_bf16 v[24:27], v[108:111], v[64:67], 0
    v_and_b32 v72, v44, v20
    v_and_b32 v73, v44, v21
    v_and_b32 v74, v44, v22
    v_and_b32 v75, v44, v23
    v_mfma_f32_16x16x32_bf16 v[24:27], v[112:115], v[68:71], v[24:27]
    v_and_b32 v76, v45, v20
    v_and_b32 v77, v45, v21
    v_and_b32 v78, v45, v22
    v_and_b32 v79, v45, v23
    v_mfma_f32_16x16x32_bf16 v[24:27], v[116:119], v[72:75], v[24:27]
    v_and_b32 v80, v46, v20
    v_and_b32 v81, v46, v21
    v_and_b32 v82, v46, v22
    v_and_b32 v83, v46, v23
    v_mfma_f32_16x16x32_bf16 v[24:27], v[120:123], v[76:79], v[24:27]
    v_and_b32 v84, v47, v20
    v_and_b32 v85, v47, v21
    v_and_b32 v86, v47, v22
    v_and_b32 v87, v47, v23
    s_waitcnt vmcnt(5)
    v_mfma_f32_16x16x32_bf16 v[24:27], v[124:127], v[80:83], v[24:27]
    v_and_b32 v88, v48, v20
    v_and_b32 v89, v48, v21
    v_and_b32 v90, v48, v22
    v_and_b32 v91, v48, v23
    s_waitcnt vmcnt(4)
    v_mfma_f32_16x16x32_bf16 v[24:27], v[128:131], v[84:87], v[24:27]
    v_and_b32 v92, v49, v20
    v_and_b32 v93, v49, v21
    v_and_b32 v94, v49, v22
    v_and_b32 v95, v49, v23
    s_waitcnt vmcnt(3)
    v_mfma_f32_16x16x32_bf16 v[24:27], v[132:135], v[88:91], v[24:27]
    v_and_b32 v96, v50, v20
    v_and_b32 v97, v50, v21
    v_and_b32 v98, v50, v22
    v_and_b32 v99, v50, v23
    s_waitcnt vmcnt(2)
    v_mfma_f32_16x16x32_bf16 v[24:27], v[136:139], v[92:95], v[24:27]
    v_and_b32 v100, v51, v20
    v_and_b32 v101, v51, v21
    v_and_b32 v102, v51, v22
    v_and_b32 v103, v51, v23
    s_waitcnt vmcnt(1)
    v_mfma_f32_16x16x32_bf16 v[24:27], v[140:143], v[96:99], v[24:27]
    v_mov_b32 v2, 1
    s_nop 0
    s_waitcnt vmcnt(0)
    v_mfma_f32_16x16x32_bf16 v[24:27], v[144:147], v[100:103], v[24:27]
    v_bfe_u32 v34, v0, 3, 1
    v_lshlrev_b32 v32, 13, v34
    v_lshrrev_b32 v35, 1, v3
    v_lshl_add_u32 v32, v35, 12, v32
    v_and_b32 v36, 1, v3
    v_lshl_add_u32 v32, v36, 7, v32
    v_and_b32 v36, 7, v0
    v_lshl_add_u32 v32, v36, 4, v32
    ds_write_b128 v30, v[24:27] offset:8192
    s_mov_b64 exec, 1
    ds_add_rtn_u32 v2, v1, v2 offset:64
    s_mov_b64 exec, -1
    v_lshlrev_b32 v30, 4, v0
    v_lshlrev_b32 v31, 3, v0
    v_lshlrev_b32 v33, 7, v34
    s_lshl_b32 s34, s29, 14
    s_lshl_b32 s36, s30, 8
    s_add_u32 s34, s34, s36
    s_add_u32 s60, s34, 0x80000
    s_add_u32 s60, s26, s60
    s_addc_u32 s61, s27, 0
    s_lshl_b32 s34, s29, 8
    s_lshl_b32 s36, s30, 3
    s_add_u32 s34, s34, s36
    s_add_u32 s62, s34, 0xc8000
    s_add_u32 s62, s26, s62
    s_addc_u32 s63, s27, 0
    s_waitcnt lgkmcnt(0)
    v_readfirstlane_b32 s34, v2
    s_cmp_lg_u32 s34, 7
    s_cbranch_scc1 L_att_done
    ds_read_b64 v[40:41], v31 offset:16384
    ds_read_b64 v[42:43], v31 offset:16896
    ds_read_b64 v[44:45], v31 offset:17408
    ds_read_b64 v[46:47], v31 offset:17920
    ds_read_b64 v[48:49], v31 offset:18432
    ds_read_b64 v[50:51], v31 offset:18944
    ds_read_b64 v[52:53], v31 offset:19456
    ds_read_b64 v[54:55], v31 offset:19968
    ds_read_b128 v[68:71], v30 offset:8192
    ds_read_b128 v[72:75], v30 offset:9216
    ds_read_b128 v[76:79], v30 offset:10240
    ds_read_b128 v[80:83], v30 offset:11264
    ds_read_b128 v[84:87], v30 offset:12288
    ds_read_b128 v[88:91], v30 offset:13312
    ds_read_b128 v[92:95], v30 offset:14336
    s_waitcnt lgkmcnt(7)
    ds_read_b128 v[96:99], v30 offset:15360
    ds_read_b32 v2, v1 offset:96
    v_max3_f32 v28, v40, v42, v44
    v_max3_f32 v28, v28, v46, v48
    v_max3_f32 v28, v28, v50, v52
    v_max_f32 v28, v28, v54
    v_and_b32 v28, s58, v28
    v_sub_f32 v40, v40, v28
    v_sub_f32 v42, v42, v28
    v_sub_f32 v44, v44, v28
    v_sub_f32 v46, v46, v28
    v_sub_f32 v48, v48, v28
    v_sub_f32 v50, v50, v28
    v_sub_f32 v52, v52, v28
    v_sub_f32 v54, v54, v28
    v_exp_f32 v40, v40
    v_exp_f32 v42, v42
    v_exp_f32 v44, v44
    v_exp_f32 v46, v46
    v_exp_f32 v48, v48
    v_exp_f32 v50, v50
    v_exp_f32 v52, v52
    v_exp_f32 v54, v54
    s_waitcnt lgkmcnt(0)
    v_mul_f32 v24, v40, v68
    v_mul_f32 v25, v40, v69
    v_mul_f32 v26, v40, v70
    v_mul_f32 v27, v40, v71
    v_fmac_f32 v24, v42, v72
    v_fmac_f32 v25, v42, v73
    v_fmac_f32 v26, v42, v74
    v_fmac_f32 v27, v42, v75
    v_fmac_f32 v24, v44, v76
    v_fmac_f32 v25, v44, v77
    v_fmac_f32 v26, v44, v78
    v_fmac_f32 v27, v44, v79
    v_fmac_f32 v24, v46, v80
    v_fmac_f32 v25, v46, v81
    v_fmac_f32 v26, v46, v82
    v_fmac_f32 v27, v46, v83
    v_fmac_f32 v24, v48, v84
    v_fmac_f32 v25, v48, v85
    v_fmac_f32 v26, v48, v86
    v_fmac_f32 v27, v48, v87
    v_fmac_f32 v24, v50, v88
    v_fmac_f32 v25, v50, v89
    v_fmac_f32 v26, v50, v90
    v_fmac_f32 v27, v50, v91
    v_fmac_f32 v24, v52, v92
    v_fmac_f32 v25, v52, v93
    v_fmac_f32 v26, v52, v94
    v_fmac_f32 v27, v52, v95
    v_fmac_f32 v24, v54, v96
    v_fmac_f32 v25, v54, v97
    v_fmac_f32 v26, v54, v98
    v_fmac_f32 v27, v54, v99
    v_bfi_b32 v24, s58, v24, v11
    v_bfi_b32 v25, s58, v25, v58
    v_bfi_b32 v26, s58, v26, v59
    v_bfi_b32 v27, s58, v27, v60
    v_add_u32 v30, 0x200000, v32
    global_store_dwordx4 v30, v[24:27], s[60:61]
    v_mul_f32 v29, v40, v41
    v_fmac_f32 v29, v42, v43
    v_fmac_f32 v29, v44, v45
    v_fmac_f32 v29, v46, v47
    v_fmac_f32 v29, v48, v49
    v_fmac_f32 v29, v50, v51
    v_fmac_f32 v29, v52, v53
    v_fmac_f32 v29, v54, v55
    v_bfi_b32 v36, s58, v28, v11
    v_bfi_b32 v37, s58, v29, v58
    v_add_u32 v31, 0x200000, v33
    s_mov_b64 exec, 0x101
    global_store_dwordx2 v31, v[36:37], s[62:63]
    v_readfirstlane_b32 s34, v2
    s_mov_b64 exec, -1
    s_cmp_lg_u32 s34, 0
    s_cbranch_scc1 L_att_done
    global_store_dwordx4 v32, v[24:27], s[60:61] sc1
    s_mov_b64 exec, 0x101
    global_store_dwordx2 v33, v[36:37], s[62:63] sc1
    s_mov_b64 exec, -1
L_att_done:
    s_lshr_b32 s37, s28, 5
    s_mul_i32 s36, s37, 9
    s_add_u32 s32, s36, s35
    s_sub_u32 s34, s35, s37
    s_add_u32 s34, s34, 3
    s_and_b32 s34, s34, 7
    s_cmp_eq_u32 s35, 8
    s_cselect_b32 s34, 8, s34
    s_add_u32 s33, s36, s34
    s_add_u32 s34, s33, 64
    s_cmp_eq_u32 s31, 1
    s_cselect_b32 s32, s33, s32
    s_cselect_b32 s33, s34, s33
    s_lshr_b32 s34, s28, 3
    s_lshl_b32 s34, s34, 1
    s_add_u32 s34, s34, s35
    s_cmp_eq_u32 s31, 0
    s_cselect_b32 s32, s34, s32
    s_cselect_b32 s33, s34, s33
    s_cmp_ge_u32 s31, 2
    s_cbranch_scc1 L_rpath
    v_bfe_u32 v7, v0, 2, 2
    v_lshl_add_u32 v8, v3, 3, v7
    v_lshlrev_b32 v8, 7, v8
    v_and_b32 v9, 3, v0
    v_lshl_add_u32 v8, v9, 3, v8
    v_and_b32 v9, 1, v3
    v_lshlrev_b32 v9, 1, v9
    v_lshrrev_b32 v7, 1, v7
    v_or_b32 v9, v9, v7
    v_lshlrev_b32 v9, 5, v9
    v_xor_b32 v12, 0, v9
    v_add_u32 v12, v12, v8
    v_xor_b32 v13, 32, v9
    v_add_u32 v13, v13, v8
    v_xor_b32 v14, 64, v9
    v_add_u32 v14, v14, v8
    v_xor_b32 v15, 96, v9
    v_add_u32 v15, v15, v8
    v_lshrrev_b32 v10, 2, v0
    v_xor_b32 v10, v10, v0
    v_and_b32 v10, 1, v10
    s_mov_b32 s39, s3
    s_lshl_b32 s34, s39, 13
    s_add_u32 s34, s34, 40960
    v_add_u32 v16, s34, v12
    v_add_u32 v17, s34, v13
    v_add_u32 v18, s34, v14
    v_add_u32 v19, s34, v15
    v_bfe_u32 v20, v0, 2, 3
    s_movk_i32 s34, 8704
    v_and_b32 v21, 3, v0
    v_lshlrev_b32 v21, 4, v21
    v_mad_u32_u24 v20, v20, s34, v21
    v_lshlrev_b32 v21, 7, v10
    v_lshl_add_u32 v21, v3, 4, v21
    v_and_b32 v22, 1, v3
    v_lshlrev_b32 v22, 2, v22
    s_mul_i32 s34, s39, 69632
    s_lshl_b32 s35, s33, 6
    s_add_u32 s34, s34, s35
    s_add_u32 s60, s34, 0x100000
    s_add_u32 s60, s26, s60
    s_addc_u32 s61, s27, 0
    s_lshl_b32 s34, s3, 2
    v_mov_b32 v48, s34
L_spin_13:
    ds_read_b32 v2, v48 offset:8
    s_waitcnt lgkmcnt(0)
    v_readfirstlane_b32 s34, v2
    s_cmp_lg_u32 s34, 0
    s_cbranch_scc1 L_spun_14
    s_branch L_spin_13
L_spun_14:
L_frag:
    ds_read_b64_tr_b16 v[64:65], v16 offset:0
    ds_read_b64_tr_b16 v[66:67], v16 offset:512
    ds_read_b64_tr_b16 v[68:69], v17 offset:0
    ds_read_b64_tr_b16 v[70:71], v17 offset:512
    ds_read_b64_tr_b16 v[72:73], v18 offset:0
    ds_read_b64_tr_b16 v[74:75], v18 offset:512
    ds_read_b64_tr_b16 v[76:77], v19 offset:0
    ds_read_b64_tr_b16 v[78:79], v19 offset:512
    ds_read_b64_tr_b16 v[80:81], v16 offset:4096
    ds_read_b64_tr_b16 v[82:83], v16 offset:4608
    ds_read_b64_tr_b16 v[84:85], v17 offset:4096
    ds_read_b64_tr_b16 v[86:87], v17 offset:4608
    ds_read_b64_tr_b16 v[88:89], v18 offset:4096
    ds_read_b64_tr_b16 v[90:91], v18 offset:4608
    s_waitcnt lgkmcnt(6)
    ds_read_b64_tr_b16 v[92:93], v19 offset:4096
    ds_read_b64_tr_b16 v[94:95], v19 offset:4608
L_spin_15:
    ds_read_b32 v2, v1 offset:4
    s_waitcnt lgkmcnt(0)
    v_readfirstlane_b32 s34, v2
    s_cmp_eq_u32 s34, 2
    s_cbranch_scc1 L_spun_16
    s_branch L_spin_15
L_spun_16:
    ds_read_b128 v[24:27], v21 offset:768
    ds_read_b128 v[28:31], v21 offset:832
    ds_read_b32 v23, v22 offset:1024
    s_waitcnt lgkmcnt(2)
    v_mfma_f32_16x16x32_bf16 v[32:35], v[24:27], v[64:67], 0
    v_mfma_f32_16x16x32_bf16 v[36:39], v[24:27], v[68:71], 0
    v_mfma_f32_16x16x32_bf16 v[40:43], v[24:27], v[72:75], 0
    v_mfma_f32_16x16x32_bf16 v[44:47], v[24:27], v[76:79], 0
    s_waitcnt lgkmcnt(1)
    v_mfma_f32_16x16x32_bf16 v[32:35], v[28:31], v[80:83], v[32:35]
    v_mfma_f32_16x16x32_bf16 v[36:39], v[28:31], v[84:87], v[36:39]
    v_mfma_f32_16x16x32_bf16 v[40:43], v[28:31], v[88:91], v[40:43]
    v_mfma_f32_16x16x32_bf16 v[44:47], v[28:31], v[92:95], v[44:47]
L_gemv_out:
    s_waitcnt lgkmcnt(0)
    s_nop 3
    v_mul_f32 v24, v23, v32
    s_nop 0
    v_mul_f32 v25, v23, v36
    s_nop 0
    v_mul_f32 v26, v23, v40
    s_nop 0
    v_mul_f32 v27, v23, v44
    v_bfi_b32 v24, s58, v24, v11
    v_bfi_b32 v25, s58, v25, v58
    v_bfi_b32 v26, s58, v26, v59
    v_bfi_b32 v27, s58, v27, v60
    s_mov_b32 exec_hi, 0
    global_store_dwordx4 v20, v[24:27], s[60:61] sc1
    s_mov_b64 exec, -1
    s_branch L_fin
L_rpath:
    s_cmp_lg_u32 s31, 2
    s_cbranch_scc1 L_fin
    s_mul_i32 s34, s32, 8704
    s_lshl_b32 s35, s3, 10
    s_add_u32 s34, s34, s35
    s_add_u32 s60, s34, 0x100000
    s_add_u32 s60, s26, s60
    s_addc_u32 s61, s27, 0
    s_cmp_eq_u32 s3, 8
    s_cselect_b32 s35, 31, 63
    v_and_b32 v16, s35, v0
    v_lshlrev_b32 v16, 4, v16
    v_and_b32 v17, 3, v0
    v_lshlrev_b32 v17, 4, v17
    s_lshl_b32 s34, s3, 6
    v_add_u32 v19, s34, v17
    s_lshr_b32 s34, s32, 3
    s_lshl_b32 s34, s34, 7
    s_bfe_u32 s35, s32, 0x10002
    s_mul_i32 s35, s35, 1152
    s_add_u32 s34, s34, s35
    s_and_b32 s35, s32, 3
    s_lshl_b32 s35, s35, 3
    s_add_u32 s34, s34, s35
    v_lshrrev_b32 v20, 3, v17
    v_add_u32 v20, s34, v20
    v_and_b32 v21, 1, v3
    v_lshrrev_b32 v22, 1, v3
    v_lshl_add_u32 v21, v21, 1, v22
    v_lshl_add_u32 v20, v21, 5, v20
    v_and_b32 v21, 3, v0
    v_lshl_add_u32 v21, v3, 2, v21
    v_lshlrev_b32 v21, 2, v21
    s_lshl_b32 s34, s3, 6
    v_add_u32 v19, s34, v21
    v_add_u32 v17, 20480, v21
L_spin_17:
    ds_read_b32 v2, v1 offset:76
    s_waitcnt lgkmcnt(0)
    v_readfirstlane_b32 s34, v2
    s_cmp_lg_u32 s34, 0
    s_cbranch_scc1 L_spun_18
    s_sleep 2
    s_branch L_spin_17
L_spun_18:
    s_mov_b32 s59, 0
L_pollR_19:
    global_load_dwordx4 v[32:35], v16, s[60:61] sc1
    s_waitcnt vmcnt(0)
    v_xor_b32 v32, s57, v32
    v_xor_b32 v33, s17, v33
    v_xor_b32 v34, s18, v34
    v_xor_b32 v35, s19, v35
    v_or3_b32 v18, v32, v33, v34
    v_or_b32 v18, v18, v35
    v_and_b32 v18, 0xff, v18
    v_cmp_ne_u32 vcc, 0, v18
    s_cbranch_vccz L_polledR_20
    s_add_u32 s59, s59, 1
    s_cmp_lt_u32 s59, 0x10000
    s_cbranch_scc0 L_polledR_20
    s_sleep 3
    s_branch L_pollR_19
L_polledR_20:
    s_cmp_lg_u32 s3, 8
    s_cbranch_scc1 L_rfull
    s_mov_b32 exec_lo, 0
    v_mov_b32 v32, 0
    v_mov_b32 v33, 0
    v_mov_b32 v34, 0
    v_mov_b32 v35, 0
    s_mov_b64 exec, -1
    s_nop 0
L_rfull:
    v_permlane32_swap_b32 v32, v33
    v_permlane32_swap_b32 v34, v35
    v_add_f32 v32, v32, v33
    v_add_f32 v34, v34, v35
    v_mov_b32 v2, 1
    s_nop 0
    v_permlane16_swap_b32 v32, v34
    v_add_f32 v32, v32, v34
    s_nop 1
    v_add_f32_dpp v32, v32, v32 row_ror:4 row_mask:0xf bank_mask:0xf
    s_nop 1
    v_add_f32_dpp v32, v32, v32 row_ror:8 row_mask:0xf bank_mask:0xf
    ds_write_b32 v19, v32 offset:20480
    s_mov_b64 exec, 1
    ds_add_rtn_u32 v2, v1, v2 offset:68
    s_mov_b64 exec, -1
    s_waitcnt lgkmcnt(0)
    v_readfirstlane_b32 s34, v2
    s_cmp_lg_u32 s34, 8
    s_cbranch_scc1 L_fin
    ds_read2_b32 v[64:65], v17 offset0:0 offset1:16
    ds_read2_b32 v[66:67], v17 offset0:32 offset1:48
    ds_read2_b32 v[68:69], v17 offset0:64 offset1:80
    ds_read2_b32 v[70:71], v17 offset0:96 offset1:112
    ds_read_b32 v72, v17 offset:512
    s_waitcnt lgkmcnt(3)
    v_add_f32 v64, v64, v65
    v_add_f32 v66, v66, v67
    s_waitcnt lgkmcnt(1)
    v_add_f32 v68, v68, v69
    v_add_f32 v70, v70, v71
    v_add_f32 v64, v64, v66
    v_add_f32 v68, v68, v70
    s_waitcnt lgkmcnt(0)
    v_add_f32 v64, v64, v72
    v_add_f32 v64, v64, v68
    v_cvt_pk_bf16_f32 v32, v64, v64
    s_mov_b32 exec_lo, 0x000f000f
    s_mov_b32 exec_hi, 0x000f000f
    global_store_short v20, v32, s[22:23]
    s_cmp_lg_u32 s32, 0
    s_cbranch_scc1 L_rdone
    s_add_u32 s34, s56, 1
    v_mov_b32 v2, s34
    s_mov_b64 exec, 1
    global_store_dword v1, v2, s[26:27]
L_rdone:
    s_mov_b64 exec, -1
    s_branch L_fin
L_aux:
    s_bfe_u32 s36, s28, 0x20003
    s_mov_b32 s60, 0x12080200
    s_mov_b32 s61, 0x86590650
    s_mov_b32 s62, 0x89670962
    s_mov_b32 s63, 0xeb60eac
    s_cmp_eq_u32 s36, 1
    s_cselect_b32 s60, 0x12080200, s60
    s_cselect_b32 s61, 0x26591650, s61
    s_cselect_b32 s62, 0x29671962, s62
    s_cselect_b32 s63, 0xeb60eac, s63
    s_cmp_eq_u32 s36, 2
    s_cselect_b32 s60, 0x12080200, s60
    s_cselect_b32 s61, 0x46593650, s61
    s_cselect_b32 s62, 0x69e859a2, s62
    s_cselect_b32 s63, 0xeb679ef, s63
    s_cmp_eq_u32 s36, 3
    s_cselect_b32 s60, 0x12080200, s60
    s_cselect_b32 s61, 0x66595650, s61
    s_cselect_b32 s62, 0x396b7662, s62
    s_cselect_b32 s63, 0xeb649b0, s63
    s_bitcmp1_b32 s28, 2
    s_cselect_b64 s[60:61], s[62:63], s[60:61]
    s_and_b32 s34, s28, 3
    s_lshl_b32 s34, s34, 4
    s_lshr_b64 s[60:61], s[60:61], s34
    s_and_b32 s38, s60, 63
    s_bfe_u32 s39, s60, 0x40006
    s_bfe_u32 s31, s60, 0x2000a
    s_bfe_u32 s35, s60, 0x4000c
    s_lshr_b32 s37, s28, 5
    s_mul_i32 s36, s37, 9
    s_add_u32 s32, s36, s35
    s_sub_u32 s34, s35, s37
    s_add_u32 s34, s34, 3
    s_and_b32 s34, s34, 7
    s_cmp_eq_u32 s35, 8
    s_cselect_b32 s34, 8, s34
    s_add_u32 s33, s36, s34
    s_add_u32 s34, s33, 64
    s_cmp_eq_u32 s31, 1
    s_cselect_b32 s32, s33, s32
    s_cselect_b32 s33, s34, s33
    s_lshr_b32 s34, s28, 3
    s_lshl_b32 s34, s34, 1
    s_add_u32 s34, s34, s35
    s_cmp_eq_u32 s31, 0
    s_cselect_b32 s32, s34, s32
    s_cselect_b32 s33, s34, s33
    v_lshrrev_b32 v4, 3, v0
    v_and_b32 v5, 7, v0
    v_and_b32 v6, 2, v4
    v_xor_b32 v5, v5, v6
    v_lshlrev_b32 v5, 4, v5
    v_xor_b32 v6, 64, v5
    v_bfe_u32 v7, v0, 2, 2
    v_lshl_add_u32 v8, v3, 3, v7
    v_lshlrev_b32 v8, 7, v8
    v_and_b32 v9, 3, v0
    v_lshl_add_u32 v8, v9, 3, v8
    v_and_b32 v9, 1, v3
    v_lshlrev_b32 v9, 1, v9
    v_lshrrev_b32 v7, 1, v7
    v_or_b32 v9, v9, v7
    v_lshlrev_b32 v9, 5, v9
    v_xor_b32 v12, 0, v9
    v_add_u32 v12, v12, v8
    v_xor_b32 v13, 32, v9
    v_add_u32 v13, v13, v8
    v_xor_b32 v14, 64, v9
    v_add_u32 v14, v14, v8
    v_xor_b32 v15, 96, v9
    v_add_u32 v15, v15, v8
    v_lshrrev_b32 v10, 2, v0
    v_xor_b32 v10, v10, v0
    v_and_b32 v10, 1, v10
    s_waitcnt lgkmcnt(0)
    s_load_dword s56, s[26:27], 0
    s_cmp_eq_u32 s3, 9
    s_cbranch_scc1 L_haux
    s_cmp_ge_u32 s31, 2
    s_cbranch_scc1 L_fin
    s_movk_i32 s34, 1152
    v_mad_u32_u24 v16, v4, s34, v5
    v_mad_u32_u24 v17, v4, s34, v6
    v_mov_b32 v18, 1
    s_mul_i32 s36, s32, 73728
    s_mov_b32 m0, 40960
    s_cmp_eq_u32 s31, 0
    s_cselect_b32 s48, s48, s54
    s_cselect_b32 s49, s49, s55
    s_mov_b32 s50, 0x510000
    s_mov_b32 s51, 0x20000
    s_cselect_b32 s50, 0x480000, s50
    s_waitcnt lgkmcnt(0)
    s_add_u32 s19, s56, 1
    s_and_b32 s57, s19, 0xff
    s_bfe_u32 s17, s19, 0x80008
    s_bfe_u32 s18, s19, 0x80010
    s_lshr_b32 s19, s19, 24
    s_xor_b32 s17, s17, s57
    s_xor_b32 s18, s18, s57
    s_xor_b32 s19, s19, s57
    s_mov_b32 s58, 0xffffff00
    v_mov_b32 v11, s57
    v_mov_b32 v58, s17
    v_mov_b32 v59, s18
    v_mov_b32 v60, s19
    s_mov_b32 s39, 8
    v_mov_b32 v50, v16
    v_mov_b32 v51, v17
    v_mov_b32 v49, 1
    s_lshl_b32 s34, s39, 13
    s_add_u32 s34, s34, 40960
    v_add_u32 v16, s34, v12
    v_add_u32 v17, s34, v13
    v_add_u32 v18, s34, v14
    v_add_u32 v19, s34, v15
    v_bfe_u32 v20, v0, 2, 3
    s_movk_i32 s34, 8704
    v_and_b32 v21, 3, v0
    v_lshlrev_b32 v21, 4, v21
    v_mad_u32_u24 v20, v20, s34, v21
    v_lshlrev_b32 v21, 7, v10
    v_lshl_add_u32 v21, v3, 4, v21
    v_and_b32 v22, 1, v3
    v_lshlrev_b32 v22, 2, v22
    s_mul_i32 s34, s39, 69632
    s_lshl_b32 s35, s33, 6
    s_add_u32 s34, s34, s35
    s_add_u32 s60, s34, 0x100000
    s_add_u32 s60, s26, s60
    s_addc_u32 s61, s27, 0
L_spin_21:
    ds_read_b32 v2, v1 offset:80
    s_waitcnt lgkmcnt(0)
    v_readfirstlane_b32 s34, v2
    s_cmp_eq_u32 s34, 8
    s_cbranch_scc1 L_spun_22
    s_sleep 2
    s_branch L_spin_21
L_spun_22:
    buffer_load_dwordx4 v50, s[48:51], s36 offen nt lds
    s_add_u32 m0, m0, 1024
    s_add_u32 s36, s36, 9216
    buffer_load_dwordx4 v51, s[48:51], s36 offen nt lds
    s_add_u32 m0, m0, 1024
    s_add_u32 s36, s36, 9216
    buffer_load_dwordx4 v50, s[48:51], s36 offen nt lds
    s_add_u32 m0, m0, 1024
    s_add_u32 s36, s36, 9216
    buffer_load_dwordx4 v51, s[48:51], s36 offen nt lds
    s_add_u32 m0, m0, 1024
    s_add_u32 s36, s36, 9216
    buffer_load_dwordx4 v50, s[48:51], s36 offen nt lds
    s_add_u32 m0, m0, 1024
    s_add_u32 s36, s36, 9216
    buffer_load_dwordx4 v51, s[48:51], s36 offen nt lds
    s_add_u32 m0, m0, 1024
    s_add_u32 s36, s36, 9216
    buffer_load_dwordx4 v50, s[48:51], s36 offen nt lds
    s_add_u32 m0, m0, 1024
    s_add_u32 s36, s36, 9216
    buffer_load_dwordx4 v51, s[48:51], s36 offen nt lds
    s_add_u32 m0, m0, 1024
    s_sub_u32 s36, s36, 64384
    buffer_load_dwordx4 v50, s[48:51], s36 offen nt lds
    s_add_u32 m0, m0, 1024
    s_add_u32 s36, s36, 9216
    buffer_load_dwordx4 v51, s[48:51], s36 offen nt lds
    s_add_u32 m0, m0, 1024
    s_add_u32 s36, s36, 9216
    buffer_load_dwordx4 v50, s[48:51], s36 offen nt lds
    s_add_u32 m0, m0, 1024
    s_add_u32 s36, s36, 9216
    buffer_load_dwordx4 v51, s[48:51], s36 offen nt lds
    s_add_u32 m0, m0, 1024
    s_add_u32 s36, s36, 9216
    buffer_load_dwordx4 v50, s[48:51], s36 offen nt lds
    s_add_u32 m0, m0, 1024
    s_add_u32 s36, s36, 9216
    buffer_load_dwordx4 v51, s[48:51], s36 offen nt lds
    s_add_u32 m0, m0, 1024
    s_add_u32 s36, s36, 9216
    buffer_load_dwordx4 v50, s[48:51], s36 offen nt lds
    s_add_u32 m0, m0, 1024
    s_add_u32 s36, s36, 9216
    buffer_load_dwordx4 v51, s[48:51], s36 offen nt lds
    s_add_u32 m0, m0, 1024
    s_sub_u32 s36, s36, 64384
    buffer_load_dwordx4 v50, s[48:51], s36 offen nt lds
    s_add_u32 m0, m0, 1024
    s_add_u32 s36, s36, 9216
    buffer_load_dwordx4 v51, s[48:51], s36 offen nt lds
    s_add_u32 m0, m0, 1024
    s_add_u32 s36, s36, 9216
    buffer_load_dwordx4 v50, s[48:51], s36 offen nt lds
    s_add_u32 m0, m0, 1024
    s_add_u32 s36, s36, 9216
    buffer_load_dwordx4 v51, s[48:51], s36 offen nt lds
    s_add_u32 m0, m0, 1024
    s_add_u32 s36, s36, 9216
    buffer_load_dwordx4 v50, s[48:51], s36 offen nt lds
    s_add_u32 m0, m0, 1024
    s_add_u32 s36, s36, 9216
    buffer_load_dwordx4 v51, s[48:51], s36 offen nt lds
    s_add_u32 m0, m0, 1024
    s_add_u32 s36, s36, 9216
    buffer_load_dwordx4 v50, s[48:51], s36 offen nt lds
    s_add_u32 m0, m0, 1024
    s_add_u32 s36, s36, 9216
    buffer_load_dwordx4 v51, s[48:51], s36 offen nt lds
    s_add_u32 m0, m0, 1024
    s_sub_u32 s36, s36, 64384
    buffer_load_dwordx4 v50, s[48:51], s36 offen nt lds
    s_add_u32 m0, m0, 1024
    s_add_u32 s36, s36, 9216
    buffer_load_dwordx4 v51, s[48:51], s36 offen nt lds
    s_add_u32 m0, m0, 1024
    s_add_u32 s36, s36, 9216
    buffer_load_dwordx4 v50, s[48:51], s36 offen nt lds
    s_add_u32 m0, m0, 1024
    s_add_u32 s36, s36, 9216
    buffer_load_dwordx4 v51, s[48:51], s36 offen nt lds
    s_add_u32 m0, m0, 1024
    s_add_u32 s36, s36, 9216
    s_waitcnt vmcnt(27)
    buffer_load_dwordx4 v50, s[48:51], s36 offen nt lds
    s_add_u32 m0, m0, 1024
    s_add_u32 s36, s36, 9216
    s_waitcnt vmcnt(27)
    buffer_load_dwordx4 v51, s[48:51], s36 offen nt lds
    s_add_u32 m0, m0, 1024
    s_add_u32 s36, s36, 9216
    s_waitcnt vmcnt(27)
    buffer_load_dwordx4 v50, s[48:51], s36 offen nt lds
    s_add_u32 m0, m0, 1024
    s_add_u32 s36, s36, 9216
    s_waitcnt vmcnt(27)
    buffer_load_dwordx4 v51, s[48:51], s36 offen nt lds
    s_add_u32 m0, m0, 1024
    s_sub_u32 s36, s36, 64384
    s_waitcnt vmcnt(27)
    buffer_load_dwordx4 v50, s[48:51], s36 offen nt lds
    s_add_u32 m0, m0, 1024
    s_add_u32 s36, s36, 9216
    s_waitcnt vmcnt(27)
    buffer_load_dwordx4 v51, s[48:51], s36 offen nt lds
    s_add_u32 m0, m0, 1024
    s_add_u32 s36, s36, 9216
    s_waitcnt vmcnt(27)
    buffer_load_dwordx4 v50, s[48:51], s36 offen nt lds
    s_add_u32 m0, m0, 1024
    s_add_u32 s36, s36, 9216
    s_waitcnt vmcnt(27)
    ds_write_b32 v1, v49 offset:8
    buffer_load_dwordx4 v51, s[48:51], s36 offen nt lds
    s_add_u32 m0, m0, 1024
    s_add_u32 s36, s36, 9216
    s_waitcnt vmcnt(27)
    buffer_load_dwordx4 v50, s[48:51], s36 offen nt lds
    s_add_u32 m0, m0, 1024
    s_add_u32 s36, s36, 9216
    s_waitcnt vmcnt(27)
    buffer_load_dwordx4 v51, s[48:51], s36 offen nt lds
    s_add_u32 m0, m0, 1024
    s_add_u32 s36, s36, 9216
    s_waitcnt vmcnt(27)
    buffer_load_dwordx4 v50, s[48:51], s36 offen nt lds
    s_add_u32 m0, m0, 1024
    s_add_u32 s36, s36, 9216
    s_waitcnt vmcnt(27)
    buffer_load_dwordx4 v51, s[48:51], s36 offen nt lds
    s_add_u32 m0, m0, 1024
    s_sub_u32 s36, s36, 64384
    s_waitcnt vmcnt(27)
    buffer_load_dwordx4 v50, s[48:51], s36 offen nt lds
    s_add_u32 m0, m0, 1024
    s_add_u32 s36, s36, 9216
    s_waitcnt vmcnt(27)
    buffer_load_dwordx4 v51, s[48:51], s36 offen nt lds
    s_add_u32 m0, m0, 1024
    s_add_u32 s36, s36, 9216
    s_waitcnt vmcnt(27)
    buffer_load_dwordx4 v50, s[48:51], s36 offen nt lds
    s_add_u32 m0, m0, 1024
    s_add_u32 s36, s36, 9216
    s_waitcnt vmcnt(27)
    ds_write_b32 v1, v49 offset:12
    buffer_load_dwordx4 v51, s[48:51], s36 offen nt lds
    s_add_u32 m0, m0, 1024
    s_add_u32 s36, s36, 9216
    s_waitcnt vmcnt(27)
    buffer_load_dwordx4 v50, s[48:51], s36 offen nt lds
    s_add_u32 m0, m0, 1024
    s_add_u32 s36, s36, 9216
    s_waitcnt vmcnt(27)
    buffer_load_dwordx4 v51, s[48:51], s36 offen nt lds
    s_add_u32 m0, m0, 1024
    s_add_u32 s36, s36, 9216
    s_waitcnt vmcnt(27)
    buffer_load_dwordx4 v50, s[48:51], s36 offen nt lds
    s_add_u32 m0, m0, 1024
    s_add_u32 s36, s36, 9216
    s_waitcnt vmcnt(27)
    buffer_load_dwordx4 v51, s[48:51], s36 offen nt lds
    s_add_u32 m0, m0, 1024
    s_sub_u32 s36, s36, 64384
    s_waitcnt vmcnt(27)
    buffer_load_dwordx4 v50, s[48:51], s36 offen nt lds
    s_add_u32 m0, m0, 1024
    s_add_u32 s36, s36, 9216
    s_waitcnt vmcnt(27)
    buffer_load_dwordx4 v51, s[48:51], s36 offen nt lds
    s_add_u32 m0, m0, 1024
    s_add_u32 s36, s36, 9216
    s_waitcnt vmcnt(27)
    buffer_load_dwordx4 v50, s[48:51], s36 offen nt lds
    s_add_u32 m0, m0, 1024
    s_add_u32 s36, s36, 9216
    s_waitcnt vmcnt(27)
    ds_write_b32 v1, v49 offset:16
    buffer_load_dwordx4 v51, s[48:51], s36 offen nt lds
    s_add_u32 m0, m0, 1024
    s_add_u32 s36, s36, 9216
    s_waitcnt vmcnt(27)
    buffer_load_dwordx4 v50, s[48:51], s36 offen nt lds
    s_add_u32 m0, m0, 1024
    s_add_u32 s36, s36, 9216
    s_waitcnt vmcnt(27)
    buffer_load_dwordx4 v51, s[48:51], s36 offen nt lds
    s_add_u32 m0, m0, 1024
    s_add_u32 s36, s36, 9216
    s_waitcnt vmcnt(27)
    buffer_load_dwordx4 v50, s[48:51], s36 offen nt lds
    s_add_u32 m0, m0, 1024
    s_add_u32 s36, s36, 9216
    s_waitcnt vmcnt(27)
    buffer_load_dwordx4 v51, s[48:51], s36 offen nt lds
    s_add_u32 m0, m0, 1024
    s_sub_u32 s36, s36, 64384
    s_waitcnt vmcnt(27)
    buffer_load_dwordx4 v50, s[48:51], s36 offen nt lds
    s_add_u32 m0, m0, 1024
    s_add_u32 s36, s36, 9216
    s_waitcnt vmcnt(27)
    buffer_load_dwordx4 v51, s[48:51], s36 offen nt lds
    s_add_u32 m0, m0, 1024
    s_add_u32 s36, s36, 9216
    s_waitcnt vmcnt(27)
    buffer_load_dwordx4 v50, s[48:51], s36 offen nt lds
    s_add_u32 m0, m0, 1024
    s_add_u32 s36, s36, 9216
    s_waitcnt vmcnt(27)
    ds_write_b32 v1, v49 offset:20
    buffer_load_dwordx4 v51, s[48:51], s36 offen nt lds
    s_add_u32 m0, m0, 1024
    s_add_u32 s36, s36, 9216
    s_waitcnt vmcnt(27)
    buffer_load_dwordx4 v50, s[48:51], s36 offen nt lds
    s_add_u32 m0, m0, 1024
    s_add_u32 s36, s36, 9216
    s_waitcnt vmcnt(27)
    buffer_load_dwordx4 v51, s[48:51], s36 offen nt lds
    s_add_u32 m0, m0, 1024
    s_add_u32 s36, s36, 9216
    s_waitcnt vmcnt(27)
    buffer_load_dwordx4 v50, s[48:51], s36 offen nt lds
    s_add_u32 m0, m0, 1024
    s_add_u32 s36, s36, 9216
    s_waitcnt vmcnt(27)
    buffer_load_dwordx4 v51, s[48:51], s36 offen nt lds
    s_add_u32 m0, m0, 1024
    s_sub_u32 s36, s36, 64384
    s_waitcnt vmcnt(27)
    buffer_load_dwordx4 v50, s[48:51], s36 offen nt lds
    s_add_u32 m0, m0, 1024
    s_add_u32 s36, s36, 9216
    s_waitcnt vmcnt(27)
    buffer_load_dwordx4 v51, s[48:51], s36 offen nt lds
    s_add_u32 m0, m0, 1024
    s_add_u32 s36, s36, 9216
    s_waitcnt vmcnt(27)
    buffer_load_dwordx4 v50, s[48:51], s36 offen nt lds
    s_add_u32 m0, m0, 1024
    s_add_u32 s36, s36, 9216
    s_waitcnt vmcnt(27)
    ds_write_b32 v1, v49 offset:24
    buffer_load_dwordx4 v51, s[48:51], s36 offen nt lds
    s_add_u32 m0, m0, 1024
    s_add_u32 s36, s36, 9216
    s_waitcnt vmcnt(27)
    buffer_load_dwordx4 v50, s[48:51], s36 offen nt lds
    s_add_u32 m0, m0, 1024
    s_add_u32 s36, s36, 9216
    s_waitcnt vmcnt(27)
    buffer_load_dwordx4 v51, s[48:51], s36 offen nt lds
    s_add_u32 m0, m0, 1024
    s_add_u32 s36, s36, 9216
    s_waitcnt vmcnt(27)
    buffer_load_dwordx4 v50, s[48:51], s36 offen nt lds
    s_add_u32 m0, m0, 1024
    s_add_u32 s36, s36, 9216
    s_waitcnt vmcnt(27)
    buffer_load_dwordx4 v51, s[48:51], s36 offen nt lds
    s_setprio 2
    s_waitcnt vmcnt(24)
    ds_write_b32 v1, v49 offset:28
    s_waitcnt vmcnt(16)
    ds_write_b32 v1, v49 offset:32
    s_waitcnt vmcnt(8)
    ds_write_b32 v1, v49 offset:36
    ds_read_b32 v2, v1 offset:4
    s_waitcnt lgkmcnt(0)
    v_readfirstlane_b32 s34, v2
    s_cmp_eq_u32 s34, 2
    s_cbranch_scc0 L_slowg
    ds_read_b128 v[24:27], v21 offset:768
    ds_read_b128 v[28:31], v21 offset:832
    ds_read_b32 v23, v22 offset:1024
    s_waitcnt vmcnt(4)
    ds_read_b64_tr_b16 v[64:65], v16 offset:0
    ds_read_b64_tr_b16 v[66:67], v16 offset:512
    ds_read_b64_tr_b16 v[68:69], v17 offset:0
    ds_read_b64_tr_b16 v[70:71], v17 offset:512
    ds_read_b64_tr_b16 v[72:73], v18 offset:0
    ds_read_b64_tr_b16 v[74:75], v18 offset:512
    ds_read_b64_tr_b16 v[76:77], v19 offset:0
    ds_read_b64_tr_b16 v[78:79], v19 offset:512
    s_waitcnt lgkmcnt(6)
    v_mfma_f32_16x16x32_bf16 v[32:35], v[24:27], v[64:67], 0
    s_waitcnt lgkmcnt(4)
    v_mfma_f32_16x16x32_bf16 v[36:39], v[24:27], v[68:71], 0
    s_waitcnt lgkmcnt(2)
    v_mfma_f32_16x16x32_bf16 v[40:43], v[24:27], v[72:75], 0
    s_waitcnt lgkmcnt(0)
    v_mfma_f32_16x16x32_bf16 v[44:47], v[24:27], v[76:79], 0
    s_waitcnt vmcnt(0)
    ds_read_b64_tr_b16 v[80:81], v16 offset:4096
    ds_read_b64_tr_b16 v[82:83], v16 offset:4608
    ds_read_b64_tr_b16 v[84:85], v17 offset:4096
    ds_read_b64_tr_b16 v[86:87], v17 offset:4608
    ds_read_b64_tr_b16 v[88:89], v18 offset:4096
    ds_read_b64_tr_b16 v[90:91], v18 offset:4608
    ds_read_b64_tr_b16 v[92:93], v19 offset:4096
    ds_read_b64_tr_b16 v[94:95], v19 offset:4608
    s_waitcnt lgkmcnt(6)
    v_mfma_f32_16x16x32_bf16 v[32:35], v[28:31], v[80:83], v[32:35]
    s_waitcnt lgkmcnt(4)
    v_mfma_f32_16x16x32_bf16 v[36:39], v[28:31], v[84:87], v[36:39]
    s_waitcnt lgkmcnt(2)
    v_mfma_f32_16x16x32_bf16 v[40:43], v[28:31], v[88:91], v[40:43]
    s_waitcnt lgkmcnt(0)
    v_mfma_f32_16x16x32_bf16 v[44:47], v[28:31], v[92:95], v[44:47]
    s_nop 2
    s_branch L_gemv_out
L_slowg:
    s_waitcnt vmcnt(0)
    s_branch L_frag
L_haux:
    s_cmp_eq_u32 s31, 3
    s_cbranch_scc1 L_fin
    s_cmp_eq_u32 s31, 2
    s_cbranch_scc1 L_h
    v_lshlrev_b32 v16, 4, v0
    s_mov_b32 m0, 5120
    s_mov_b32 s22, 0x480
    s_mov_b32 s23, 0x20000
    buffer_load_dwordx4 v16, s[20:23], 0 offen offset:0 lds
    buffer_load_dwordx4 v16, s[20:23], 0 offen offset:1024 lds
    v_and_b32 v16, 31, v0
    v_lshlrev_b32 v16, 2, v16
    v_lshrrev_b32 v17, 5, v0
    s_movk_i32 s34, 1152
    v_mad_u32_u24 v17, v17, s34, v16
L_spin_23:
    ds_read_b32 v2, v1 offset:88
    s_waitcnt lgkmcnt(0)
    v_readfirstlane_b32 s34, v2
    s_cmp_lg_u32 s34, 0
    s_cbranch_scc1 L_spun_24
    s_sleep 2
    s_branch L_spin_23
L_spun_24:
    s_waitcnt vmcnt(0)
    ds_read_b32 v64, v17 offset:2048
    ds_read_b32 v65, v17 offset:2176
    ds_read_b32 v66, v17 offset:2304
    ds_read_b32 v67, v17 offset:2432
    ds_read_b32 v68, v17 offset:2560
    ds_read_b32 v69, v17 offset:2688
    ds_read_b32 v70, v17 offset:2816
    s_waitcnt lgkmcnt(4)
    ds_read_b32 v71, v17 offset:2944
    ds_read_b32 v72, v17 offset:3072
    ds_read_b32 v76, v16 offset:5120
    ds_read_b32 v77, v16 offset:5248
    ds_read_b32 v78, v16 offset:5376
    s_waitcnt lgkmcnt(6)
    ds_read_b32 v79, v16 offset:5504
    ds_read_b32 v80, v16 offset:5632
    ds_read_b32 v81, v16 offset:5760
    ds_read_b32 v82, v16 offset:5888
    s_waitcnt lgkmcnt(6)
    ds_read_b32 v83, v16 offset:6016
    ds_read_b32 v84, v16 offset:6144
    s_mov_b32 s35, 0xffff0000
    v_mov_b32 v18, 0
    s_waitcnt lgkmcnt(0)
    v_lshlrev_b32 v20, 16, v64
    v_and_b32 v21, s35, v64
    v_lshlrev_b32 v22, 16, v76
    v_and_b32 v23, s35, v76
    v_mul_f32 v20, v20, v22
    v_mul_f32 v21, v21, v23
    v_cvt_pk_bf16_f32 v20, v20, v21
    v_lshlrev_b32 v21, 16, v20
    v_and_b32 v20, s35, v20
    v_add_f32 v18, v18, v21
    v_add_f32 v18, v18, v20
    v_lshlrev_b32 v20, 16, v65
    v_and_b32 v21, s35, v65
    v_lshlrev_b32 v22, 16, v77
    v_and_b32 v23, s35, v77
    v_mul_f32 v20, v20, v22
    v_mul_f32 v21, v21, v23
    v_cvt_pk_bf16_f32 v20, v20, v21
    v_lshlrev_b32 v21, 16, v20
    v_and_b32 v20, s35, v20
    v_add_f32 v18, v18, v21
    v_add_f32 v18, v18, v20
    v_lshlrev_b32 v20, 16, v66
    v_and_b32 v21, s35, v66
    v_lshlrev_b32 v22, 16, v78
    v_and_b32 v23, s35, v78
    v_mul_f32 v20, v20, v22
    v_mul_f32 v21, v21, v23
    v_cvt_pk_bf16_f32 v20, v20, v21
    v_lshlrev_b32 v21, 16, v20
    v_and_b32 v20, s35, v20
    v_add_f32 v18, v18, v21
    v_add_f32 v18, v18, v20
    v_lshlrev_b32 v20, 16, v67
    v_and_b32 v21, s35, v67
    v_lshlrev_b32 v22, 16, v79
    v_and_b32 v23, s35, v79
    v_mul_f32 v20, v20, v22
    v_mul_f32 v21, v21, v23
    v_cvt_pk_bf16_f32 v20, v20, v21
    v_lshlrev_b32 v21, 16, v20
    v_and_b32 v20, s35, v20
    v_add_f32 v18, v18, v21
    v_add_f32 v18, v18, v20
    v_lshlrev_b32 v20, 16, v68
    v_and_b32 v21, s35, v68
    v_lshlrev_b32 v22, 16, v80
    v_and_b32 v23, s35, v80
    v_mul_f32 v20, v20, v22
    v_mul_f32 v21, v21, v23
    v_cvt_pk_bf16_f32 v20, v20, v21
    v_lshlrev_b32 v21, 16, v20
    v_and_b32 v20, s35, v20
    v_add_f32 v18, v18, v21
    v_add_f32 v18, v18, v20
    v_lshlrev_b32 v20, 16, v69
    v_and_b32 v21, s35, v69
    v_lshlrev_b32 v22, 16, v81
    v_and_b32 v23, s35, v81
    v_mul_f32 v20, v20, v22
    v_mul_f32 v21, v21, v23
    v_cvt_pk_bf16_f32 v20, v20, v21
    v_lshlrev_b32 v21, 16, v20
    v_and_b32 v20, s35, v20
    v_add_f32 v18, v18, v21
    v_add_f32 v18, v18, v20
    v_lshlrev_b32 v20, 16, v70
    v_and_b32 v21, s35, v70
    v_lshlrev_b32 v22, 16, v82
    v_and_b32 v23, s35, v82
    v_mul_f32 v20, v20, v22
    v_mul_f32 v21, v21, v23
    v_cvt_pk_bf16_f32 v20, v20, v21
    v_lshlrev_b32 v21, 16, v20
    v_and_b32 v20, s35, v20
    v_add_f32 v18, v18, v21
    v_add_f32 v18, v18, v20
    v_lshlrev_b32 v20, 16, v71
    v_and_b32 v21, s35, v71
    v_lshlrev_b32 v22, 16, v83
    v_and_b32 v23, s35, v83
    v_mul_f32 v20, v20, v22
    v_mul_f32 v21, v21, v23
    v_cvt_pk_bf16_f32 v20, v20, v21
    v_lshlrev_b32 v21, 16, v20
    v_and_b32 v20, s35, v20
    v_add_f32 v18, v18, v21
    v_add_f32 v18, v18, v20
    v_lshlrev_b32 v20, 16, v72
    v_and_b32 v21, s35, v72
    v_lshlrev_b32 v22, 16, v84
    v_and_b32 v23, s35, v84
    v_mul_f32 v20, v20, v22
    v_mul_f32 v21, v21, v23
    v_cvt_pk_bf16_f32 v20, v20, v21
    v_lshlrev_b32 v21, 16, v20
    v_and_b32 v20, s35, v20
    v_add_f32 v18, v18, v21
    v_add_f32 v18, v18, v20
    s_nop 1
    v_add_f32_dpp v18, v18, v18 row_ror:1 row_mask:0xf bank_mask:0xf
    s_nop 1
    v_add_f32_dpp v18, v18, v18 row_ror:2 row_mask:0xf bank_mask:0xf
    s_nop 1
    v_add_f32_dpp v18, v18, v18 row_ror:4 row_mask:0xf bank_mask:0xf
    s_nop 1
    v_add_f32_dpp v18, v18, v18 row_ror:8 row_mask:0xf bank_mask:0xf
    s_nop 1
    v_mov_b32 v19, v18
    s_nop 1
    v_permlane16_swap_b32 v18, v19
    v_add_f32 v18, v18, v19
    v_cvt_pk_bf16_f32 v18, v18, v18
    v_and_b32 v18, s35, v18
    v_mul_f32 v18, 0xbfb8aa3b, v18
    v_exp_f32 v18, v18
    s_nop 0
    v_add_f32 v18, 1.0, v18
    v_rcp_f32 v18, v18
    s_nop 0
    v_cvt_pk_bf16_f32 v18, v18, v18
    v_and_b32 v18, s35, v18
    v_sub_f32 v19, 1.0, v18
    v_cvt_pk_bf16_f32 v19, v19, v19
    v_and_b32 v19, s35, v19
    v_lshrrev_b32 v17, 5, v0
    v_lshlrev_b32 v17, 2, v17
    s_cmp_eq_u32 s31, 0
    s_cselect_b64 vcc, -1, 0
    v_cndmask_b32 v18, v19, v18, vcc
    ds_write_b32 v17, v18 offset:1024
    v_mov_b32 v2, 1
    s_mov_b64 exec, 1
    ds_add_u32 v1, v2 offset:4
    s_mov_b64 exec, -1
    s_branch L_fin
L_h:
    s_movk_i32 s34, 9216
    v_mad_u32_u24 v50, v4, s34, v5
    v_mad_u32_u24 v51, v4, s34, v6
    s_lshl_b32 s37, s33, 7
    s_mov_b32 s54, 0x510000
    s_mov_b32 s55, 0x20000
    s_lshl_b32 s34, s33, 9
    s_add_u32 s60, s34, 0x40000
    s_add_u32 s60, s26, s60
    s_addc_u32 s61, s27, 0
    s_setprio 2
    s_mov_b32 m0, 40960
    s_waitcnt lgkmcnt(0)
    s_add_u32 s19, s56, 1
    s_and_b32 s57, s19, 0xff
    s_bfe_u32 s17, s19, 0x80008
    s_bfe_u32 s18, s19, 0x80010
    s_lshr_b32 s19, s19, 24
    s_xor_b32 s17, s17, s57
    s_xor_b32 s18, s18, s57
    s_xor_b32 s19, s19, s57
    s_mov_b32 s58, 0xffffff00
    v_mov_b32 v11, s57
    v_mov_b32 v58, s17
    v_mov_b32 v59, s18
    v_mov_b32 v60, s19
L_spin_25:
    ds_read_b32 v2, v1 offset:88
    s_waitcnt lgkmcnt(0)
    v_readfirstlane_b32 s34, v2
    s_cmp_lg_u32 s34, 0
    s_cbranch_scc1 L_spun_26
    s_sleep 4
    s_branch L_spin_25
L_spun_26:
L_spin_27:
    ds_read_b32 v2, v1 offset:80
    s_waitcnt lgkmcnt(0)
    v_readfirstlane_b32 s34, v2
    s_cmp_eq_u32 s34, 8
    s_cbranch_scc1 L_spun_28
    s_sleep 2
    s_branch L_spin_27
L_spun_28:
    buffer_load_dwordx4 v50, s[52:55], s37 offen nt lds
    s_add_u32 m0, m0, 1024
    s_add_u32 s37, s37, 73728
    buffer_load_dwordx4 v51, s[52:55], s37 offen nt lds
    s_add_u32 m0, m0, 1024
    s_add_u32 s37, s37, 73728
    buffer_load_dwordx4 v50, s[52:55], s37 offen nt lds
    s_add_u32 m0, m0, 1024
    s_add_u32 s37, s37, 73728
    buffer_load_dwordx4 v51, s[52:55], s37 offen nt lds
    s_add_u32 m0, m0, 1024
    s_add_u32 s37, s37, 73728
    buffer_load_dwordx4 v50, s[52:55], s37 offen nt lds
    s_add_u32 m0, m0, 1024
    s_add_u32 s37, s37, 73728
    buffer_load_dwordx4 v51, s[52:55], s37 offen nt lds
    s_add_u32 m0, m0, 1024
    s_add_u32 s37, s37, 73728
    buffer_load_dwordx4 v50, s[52:55], s37 offen nt lds
    s_add_u32 m0, m0, 1024
    s_add_u32 s37, s37, 73728
    buffer_load_dwordx4 v51, s[52:55], s37 offen nt lds
    s_add_u32 m0, m0, 1024
    s_add_u32 s37, s37, 73728
    buffer_load_dwordx4 v50, s[52:55], s37 offen nt lds
    s_add_u32 m0, m0, 1024
    s_add_u32 s37, s37, 73728
    buffer_load_dwordx4 v51, s[52:55], s37 offen nt lds
    s_add_u32 m0, m0, 1024
    s_add_u32 s37, s37, 73728
    buffer_load_dwordx4 v50, s[52:55], s37 offen nt lds
    s_add_u32 m0, m0, 1024
    s_add_u32 s37, s37, 73728
    buffer_load_dwordx4 v51, s[52:55], s37 offen nt lds
    s_add_u32 m0, m0, 1024
    s_add_u32 s37, s37, 73728
    buffer_load_dwordx4 v50, s[52:55], s37 offen nt lds
    s_add_u32 m0, m0, 1024
    s_add_u32 s37, s37, 73728
    buffer_load_dwordx4 v51, s[52:55], s37 offen nt lds
    s_add_u32 m0, m0, 1024
    s_add_u32 s37, s37, 73728
    buffer_load_dwordx4 v50, s[52:55], s37 offen nt lds
    s_add_u32 m0, m0, 1024
    s_add_u32 s37, s37, 73728
    buffer_load_dwordx4 v51, s[52:55], s37 offen nt lds
    s_add_u32 m0, m0, 1024
    s_add_u32 s37, s37, 73728
    buffer_load_dwordx4 v50, s[52:55], s37 offen nt lds
    s_add_u32 m0, m0, 1024
    s_add_u32 s37, s37, 73728
    buffer_load_dwordx4 v51, s[52:55], s37 offen nt lds
    s_add_u32 m0, m0, 1024
    s_add_u32 s37, s37, 73728
    buffer_load_dwordx4 v50, s[52:55], s37 offen nt lds
    s_add_u32 m0, m0, 1024
    s_add_u32 s37, s37, 73728
    buffer_load_dwordx4 v51, s[52:55], s37 offen nt lds
    s_add_u32 m0, m0, 1024
    s_add_u32 s37, s37, 73728
    buffer_load_dwordx4 v50, s[52:55], s37 offen nt lds
    s_add_u32 m0, m0, 1024
    s_add_u32 s37, s37, 73728
    buffer_load_dwordx4 v51, s[52:55], s37 offen nt lds
    s_add_u32 m0, m0, 1024
    s_add_u32 s37, s37, 73728
    buffer_load_dwordx4 v50, s[52:55], s37 offen nt lds
    s_add_u32 m0, m0, 1024
    s_add_u32 s37, s37, 73728
    buffer_load_dwordx4 v51, s[52:55], s37 offen nt lds
    s_add_u32 m0, m0, 1024
    s_add_u32 s37, s37, 73728
    buffer_load_dwordx4 v50, s[52:55], s37 offen nt lds
    s_add_u32 m0, m0, 1024
    s_add_u32 s37, s37, 73728
    buffer_load_dwordx4 v51, s[52:55], s37 offen nt lds
    s_add_u32 m0, m0, 1024
    s_add_u32 s37, s37, 73728
    buffer_load_dwordx4 v50, s[52:55], s37 offen nt lds
    s_add_u32 m0, m0, 1024
    s_add_u32 s37, s37, 73728
    buffer_load_dwordx4 v51, s[52:55], s37 offen nt lds
    s_add_u32 m0, m0, 1024
    s_add_u32 s37, s37, 73728
    buffer_load_dwordx4 v50, s[52:55], s37 offen nt lds
    s_add_u32 m0, m0, 1024
    s_add_u32 s37, s37, 73728
    buffer_load_dwordx4 v51, s[52:55], s37 offen nt lds
    s_add_u32 m0, m0, 1024
    s_add_u32 s37, s37, 73728
    buffer_load_dwordx4 v50, s[52:55], s37 offen nt lds
    s_add_u32 m0, m0, 1024
    s_add_u32 s37, s37, 73728
    buffer_load_dwordx4 v51, s[52:55], s37 offen nt lds
    s_add_u32 m0, m0, 1024
    s_add_u32 s37, s37, 73728
    buffer_load_dwordx4 v50, s[52:55], s37 offen nt lds
    s_add_u32 m0, m0, 1024
    s_add_u32 s37, s37, 73728
    buffer_load_dwordx4 v51, s[52:55], s37 offen nt lds
    s_add_u32 m0, m0, 1024
    s_add_u32 s37, s37, 73728
    buffer_load_dwordx4 v50, s[52:55], s37 offen nt lds
    s_add_u32 m0, m0, 1024
    s_add_u32 s37, s37, 73728
    buffer_load_dwordx4 v51, s[52:55], s37 offen nt lds
    s_movk_i32 s34, 1152
    v_mul_lo_u32 v16, v10, s34
    v_lshl_add_u32 v16, v3, 4, v16
    v_add_u32 v20, 40960, v12
    v_add_u32 v21, 40960, v13
    v_add_u32 v22, 40960, v14
    v_add_u32 v23, 40960, v15
    v_add_u32 v52, 102400, v12
    v_add_u32 v53, 102400, v13
    v_add_u32 v54, 102400, v14
    v_add_u32 v55, 102400, v15
    s_waitcnt vmcnt(32)
    ds_read_b128 v[24:27], v16 offset:2048
    ds_read_b64_tr_b16 v[64:65], v20 offset:0
    ds_read_b64_tr_b16 v[66:67], v20 offset:512
    ds_read_b64_tr_b16 v[68:69], v21 offset:0
    ds_read_b64_tr_b16 v[70:71], v21 offset:512
    ds_read_b64_tr_b16 v[72:73], v22 offset:0
    ds_read_b64_tr_b16 v[74:75], v22 offset:512
    ds_read_b64_tr_b16 v[76:77], v23 offset:0
    ds_read_b64_tr_b16 v[78:79], v23 offset:512
    s_waitcnt vmcnt(28)
    ds_read_b128 v[28:31], v16 offset:2112
    ds_read_b64_tr_b16 v[80:81], v20 offset:4096
    ds_read_b64_tr_b16 v[82:83], v20 offset:4608
    ds_read_b64_tr_b16 v[84:85], v21 offset:4096
    ds_read_b64_tr_b16 v[86:87], v21 offset:4608
    s_waitcnt lgkmcnt(11)
    v_mfma_f32_16x16x32_bf16 v[32:35], v[24:27], v[64:67], 0
    ds_read_b64_tr_b16 v[88:89], v22 offset:4096
    ds_read_b64_tr_b16 v[90:91], v22 offset:4608
    s_waitcnt lgkmcnt(11)
    v_mfma_f32_16x16x32_bf16 v[36:39], v[24:27], v[68:71], 0
    s_add_u32 m0, m0, 1024
    s_add_u32 s37, s37, 73728
    buffer_load_dwordx4 v50, s[52:55], s37 offen nt lds
    s_add_u32 m0, m0, 1024
    s_add_u32 s37, s37, 73728
    buffer_load_dwordx4 v51, s[52:55], s37 offen nt lds
    s_add_u32 m0, m0, 1024
    s_add_u32 s37, s37, 73728
    buffer_load_dwordx4 v50, s[52:55], s37 offen nt lds
    s_add_u32 m0, m0, 1024
    s_add_u32 s37, s37, 73728
    buffer_load_dwordx4 v51, s[52:55], s37 offen nt lds
    ds_read_b64_tr_b16 v[64:65], v23 offset:4096
    ds_read_b64_tr_b16 v[66:67], v23 offset:4608
    s_waitcnt lgkmcnt(11)
    v_mfma_f32_16x16x32_bf16 v[40:43], v[24:27], v[72:75], 0
    s_waitcnt vmcnt(28)
    ds_read_b128 v[100:103], v16 offset:2176
    ds_read_b64_tr_b16 v[68:69], v20 offset:8192
    ds_read_b64_tr_b16 v[70:71], v20 offset:8704
    s_waitcnt lgkmcnt(12)
    v_mfma_f32_16x16x32_bf16 v[44:47], v[24:27], v[76:79], 0
    ds_read_b64_tr_b16 v[72:73], v21 offset:8192
    ds_read_b64_tr_b16 v[74:75], v21 offset:8704
    s_waitcnt lgkmcnt(11)
    v_mfma_f32_16x16x32_bf16 v[32:35], v[28:31], v[80:83], v[32:35]
    ds_read_b64_tr_b16 v[76:77], v22 offset:8192
    ds_read_b64_tr_b16 v[78:79], v22 offset:8704
    s_waitcnt lgkmcnt(11)
    v_mfma_f32_16x16x32_bf16 v[36:39], v[28:31], v[84:87], v[36:39]
    s_add_u32 m0, m0, 1024
    s_add_u32 s37, s37, 73728
    buffer_load_dwordx4 v50, s[52:55], s37 offen nt lds
    s_add_u32 m0, m0, 1024
    s_add_u32 s37, s37, 73728
    buffer_load_dwordx4 v51, s[52:55], s37 offen nt lds
    s_add_u32 m0, m0, 1024
    s_add_u32 s37, s37, 73728
    buffer_load_dwordx4 v50, s[52:55], s37 offen nt lds
    s_add_u32 m0, m0, 1024
    s_add_u32 s37, s37, 73728
    buffer_load_dwordx4 v51, s[52:55], s37 offen nt lds
    ds_read_b64_tr_b16 v[80:81], v23 offset:8192
    ds_read_b64_tr_b16 v[82:83], v23 offset:8704
    s_waitcnt lgkmcnt(11)
    v_mfma_f32_16x16x32_bf16 v[40:43], v[28:31], v[88:91], v[40:43]
    s_waitcnt vmcnt(28)
    ds_read_b128 v[24:27], v16 offset:2240
    ds_read_b64_tr_b16 v[84:85], v20 offset:12288
    ds_read_b64_tr_b16 v[86:87], v20 offset:12800
    s_waitcnt lgkmcnt(12)
    v_mfma_f32_16x16x32_bf16 v[44:47], v[28:31], v[64:67], v[44:47]
    ds_read_b64_tr_b16 v[88:89], v21 offset:12288
    ds_read_b64_tr_b16 v[90:91], v21 offset:12800
    s_waitcnt lgkmcnt(11)
    v_mfma_f32_16x16x32_bf16 v[32:35], v[100:103], v[68:71], v[32:35]
    ds_read_b64_tr_b16 v[64:65], v22 offset:12288
    ds_read_b64_tr_b16 v[66:67], v22 offset:12800
    s_waitcnt lgkmcnt(11)
    v_mfma_f32_16x16x32_bf16 v[36:39], v[100:103], v[72:75], v[36:39]
    s_add_u32 m0, m0, 1024
    s_add_u32 s37, s37, 73728
    buffer_load_dwordx4 v50, s[52:55], s37 offen nt lds
    s_add_u32 m0, m0, 1024
    s_add_u32 s37, s37, 73728
    buffer_load_dwordx4 v51, s[52:55], s37 offen nt lds
    s_add_u32 m0, m0, 1024
    s_add_u32 s37, s37, 73728
    buffer_load_dwordx4 v50, s[52:55], s37 offen nt lds
    s_add_u32 m0, m0, 1024
    s_add_u32 s37, s37, 73728
    buffer_load_dwordx4 v51, s[52:55], s37 offen nt lds
    ds_read_b64_tr_b16 v[68:69], v23 offset:12288
    ds_read_b64_tr_b16 v[70:71], v23 offset:12800
    s_waitcnt lgkmcnt(11)
    v_mfma_f32_16x16x32_bf16 v[40:43], v[100:103], v[76:79], v[40:43]
    s_waitcnt vmcnt(28)
    ds_read_b128 v[28:31], v16 offset:2304
    ds_read_b64_tr_b16 v[72:73], v20 offset:16384
    ds_read_b64_tr_b16 v[74:75], v20 offset:16896
    s_waitcnt lgkmcnt(12)
    v_mfma_f32_16x16x32_bf16 v[44:47], v[100:103], v[80:83], v[44:47]
    ds_read_b64_tr_b16 v[76:77], v21 offset:16384
    ds_read_b64_tr_b16 v[78:79], v21 offset:16896
    s_waitcnt lgkmcnt(11)
    v_mfma_f32_16x16x32_bf16 v[32:35], v[24:27], v[84:87], v[32:35]
    ds_read_b64_tr_b16 v[80:81], v22 offset:16384
    ds_read_b64_tr_b16 v[82:83], v22 offset:16896
    s_waitcnt lgkmcnt(11)
    v_mfma_f32_16x16x32_bf16 v[36:39], v[24:27], v[88:91], v[36:39]
    s_add_u32 m0, m0, 1024
    s_add_u32 s37, s37, 73728
    buffer_load_dwordx4 v50, s[52:55], s37 offen nt lds
    s_add_u32 m0, m0, 1024
    s_add_u32 s37, s37, 73728
    buffer_load_dwordx4 v51, s[52:55], s37 offen nt lds
    s_add_u32 m0, m0, 1024
    s_add_u32 s37, s37, 73728
    buffer_load_dwordx4 v50, s[52:55], s37 offen nt lds
    s_add_u32 m0, m0, 1024
    s_add_u32 s37, s37, 73728
    buffer_load_dwordx4 v51, s[52:55], s37 offen nt lds
    ds_read_b64_tr_b16 v[84:85], v23 offset:16384
    ds_read_b64_tr_b16 v[86:87], v23 offset:16896
    s_waitcnt lgkmcnt(11)
    v_mfma_f32_16x16x32_bf16 v[40:43], v[24:27], v[64:67], v[40:43]
    s_waitcnt vmcnt(28)
    ds_read_b128 v[100:103], v16 offset:2368
    ds_read_b64_tr_b16 v[88:89], v20 offset:20480
    ds_read_b64_tr_b16 v[90:91], v20 offset:20992
    s_waitcnt lgkmcnt(12)
    v_mfma_f32_16x16x32_bf16 v[44:47], v[24:27], v[68:71], v[44:47]
    ds_read_b64_tr_b16 v[64:65], v21 offset:20480
    ds_read_b64_tr_b16 v[66:67], v21 offset:20992
    s_waitcnt lgkmcnt(11)
    v_mfma_f32_16x16x32_bf16 v[32:35], v[28:31], v[72:75], v[32:35]
    ds_read_b64_tr_b16 v[68:69], v22 offset:20480
    ds_read_b64_tr_b16 v[70:71], v22 offset:20992
    s_waitcnt lgkmcnt(11)
    v_mfma_f32_16x16x32_bf16 v[36:39], v[28:31], v[76:79], v[36:39]
    s_add_u32 m0, m0, 1024
    s_add_u32 s37, s37, 73728
    buffer_load_dwordx4 v50, s[52:55], s37 offen nt lds
    s_add_u32 m0, m0, 1024
    s_add_u32 s37, s37, 73728
    buffer_load_dwordx4 v51, s[52:55], s37 offen nt lds
    s_add_u32 m0, m0, 1024
    s_add_u32 s37, s37, 73728
    buffer_load_dwordx4 v50, s[52:55], s37 offen nt lds
    s_add_u32 m0, m0, 1024
    s_add_u32 s37, s37, 73728
    buffer_load_dwordx4 v51, s[52:55], s37 offen nt lds
    ds_read_b64_tr_b16 v[72:73], v23 offset:20480
    ds_read_b64_tr_b16 v[74:75], v23 offset:20992
    s_waitcnt lgkmcnt(11)
    v_mfma_f32_16x16x32_bf16 v[40:43], v[28:31], v[80:83], v[40:43]
    s_waitcnt vmcnt(28)
    ds_read_b128 v[24:27], v16 offset:2432
    ds_read_b64_tr_b16 v[76:77], v20 offset:24576
    ds_read_b64_tr_b16 v[78:79], v20 offset:25088
    s_waitcnt lgkmcnt(12)
    v_mfma_f32_16x16x32_bf16 v[44:47], v[28:31], v[84:87], v[44:47]
    ds_read_b64_tr_b16 v[80:81], v21 offset:24576
    ds_read_b64_tr_b16 v[82:83], v21 offset:25088
    s_waitcnt lgkmcnt(11)
    v_mfma_f32_16x16x32_bf16 v[32:35], v[100:103], v[88:91], v[32:35]
    ds_read_b64_tr_b16 v[84:85], v22 offset:24576
    ds_read_b64_tr_b16 v[86:87], v22 offset:25088
    s_waitcnt lgkmcnt(11)
    v_mfma_f32_16x16x32_bf16 v[36:39], v[100:103], v[64:67], v[36:39]
    s_add_u32 m0, m0, 1024
    s_add_u32 s37, s37, 73728
    buffer_load_dwordx4 v50, s[52:55], s37 offen nt lds
    s_add_u32 m0, m0, 1024
    s_add_u32 s37, s37, 73728
    buffer_load_dwordx4 v51, s[52:55], s37 offen nt lds
    s_add_u32 m0, m0, 1024
    s_add_u32 s37, s37, 73728
    buffer_load_dwordx4 v50, s[52:55], s37 offen nt lds
    s_add_u32 m0, m0, 1024
    s_add_u32 s37, s37, 73728
    buffer_load_dwordx4 v51, s[52:55], s37 offen nt lds
    ds_read_b64_tr_b16 v[88:89], v23 offset:24576
    ds_read_b64_tr_b16 v[90:91], v23 offset:25088
    s_waitcnt lgkmcnt(11)
    v_mfma_f32_16x16x32_bf16 v[40:43], v[100:103], v[68:71], v[40:43]
    s_waitcnt vmcnt(28)
    ds_read_b128 v[28:31], v16 offset:2496
    ds_read_b64_tr_b16 v[64:65], v20 offset:28672
    ds_read_b64_tr_b16 v[66:67], v20 offset:29184
    s_waitcnt lgkmcnt(12)
    v_mfma_f32_16x16x32_bf16 v[44:47], v[100:103], v[72:75], v[44:47]
    ds_read_b64_tr_b16 v[68:69], v21 offset:28672
    ds_read_b64_tr_b16 v[70:71], v21 offset:29184
    s_waitcnt lgkmcnt(11)
    v_mfma_f32_16x16x32_bf16 v[32:35], v[24:27], v[76:79], v[32:35]
    ds_read_b64_tr_b16 v[72:73], v22 offset:28672
    ds_read_b64_tr_b16 v[74:75], v22 offset:29184
    s_waitcnt lgkmcnt(11)
    v_mfma_f32_16x16x32_bf16 v[36:39], v[24:27], v[80:83], v[36:39]
    s_add_u32 m0, m0, 1024
    s_add_u32 s37, s37, 73728
    buffer_load_dwordx4 v50, s[52:55], s37 offen nt lds
    s_add_u32 m0, m0, 1024
    s_add_u32 s37, s37, 73728
    buffer_load_dwordx4 v51, s[52:55], s37 offen nt lds
    s_add_u32 m0, m0, 1024
    s_add_u32 s37, s37, 73728
    buffer_load_dwordx4 v50, s[52:55], s37 offen nt lds
    s_add_u32 m0, m0, 1024
    s_add_u32 s37, s37, 73728
    buffer_load_dwordx4 v51, s[52:55], s37 offen nt lds
    ds_read_b64_tr_b16 v[76:77], v23 offset:28672
    ds_read_b64_tr_b16 v[78:79], v23 offset:29184
    s_waitcnt lgkmcnt(11)
    v_mfma_f32_16x16x32_bf16 v[40:43], v[24:27], v[84:87], v[40:43]
    s_waitcnt vmcnt(28)
    ds_read_b128 v[100:103], v16 offset:2560
    ds_read_b64_tr_b16 v[80:81], v20 offset:32768
    ds_read_b64_tr_b16 v[82:83], v20 offset:33280
    s_waitcnt lgkmcnt(12)
    v_mfma_f32_16x16x32_bf16 v[44:47], v[24:27], v[88:91], v[44:47]
    ds_read_b64_tr_b16 v[84:85], v21 offset:32768
    ds_read_b64_tr_b16 v[86:87], v21 offset:33280
    s_waitcnt lgkmcnt(11)
    v_mfma_f32_16x16x32_bf16 v[32:35], v[28:31], v[64:67], v[32:35]
    ds_read_b64_tr_b16 v[88:89], v22 offset:32768
    ds_read_b64_tr_b16 v[90:91], v22 offset:33280
    s_waitcnt lgkmcnt(11)
    v_mfma_f32_16x16x32_bf16 v[36:39], v[28:31], v[68:71], v[36:39]
    s_add_u32 m0, m0, 1024
    s_add_u32 s37, s37, 73728
    buffer_load_dwordx4 v50, s[52:55], s37 offen nt lds
    s_add_u32 m0, m0, 1024
    s_add_u32 s37, s37, 73728
    buffer_load_dwordx4 v51, s[52:55], s37 offen nt lds
    s_add_u32 m0, m0, 1024
    s_add_u32 s37, s37, 73728
    buffer_load_dwordx4 v50, s[52:55], s37 offen nt lds
    s_add_u32 m0, m0, 1024
    s_add_u32 s37, s37, 73728
    buffer_load_dwordx4 v51, s[52:55], s37 offen nt lds
    ds_read_b64_tr_b16 v[64:65], v23 offset:32768
    ds_read_b64_tr_b16 v[66:67], v23 offset:33280
    s_waitcnt lgkmcnt(11)
    v_mfma_f32_16x16x32_bf16 v[40:43], v[28:31], v[72:75], v[40:43]
    s_waitcnt vmcnt(28)
    ds_read_b128 v[24:27], v16 offset:2624
    ds_read_b64_tr_b16 v[68:69], v20 offset:36864
    ds_read_b64_tr_b16 v[70:71], v20 offset:37376
    s_waitcnt lgkmcnt(12)
    v_mfma_f32_16x16x32_bf16 v[44:47], v[28:31], v[76:79], v[44:47]
    ds_read_b64_tr_b16 v[72:73], v21 offset:36864
    ds_read_b64_tr_b16 v[74:75], v21 offset:37376
    s_waitcnt lgkmcnt(11)
    v_mfma_f32_16x16x32_bf16 v[32:35], v[100:103], v[80:83], v[32:35]
    ds_read_b64_tr_b16 v[76:77], v22 offset:36864
    ds_read_b64_tr_b16 v[78:79], v22 offset:37376
    s_waitcnt lgkmcnt(11)
    v_mfma_f32_16x16x32_bf16 v[36:39], v[100:103], v[84:87], v[36:39]
    s_add_u32 m0, m0, 1024
    s_add_u32 s37, s37, 73728
    buffer_load_dwordx4 v50, s[52:55], s37 offen nt lds
    s_add_u32 m0, m0, 1024
    s_add_u32 s37, s37, 73728
    buffer_load_dwordx4 v51, s[52:55], s37 offen nt lds
    s_add_u32 m0, m0, 1024
    s_add_u32 s37, s37, 73728
    buffer_load_dwordx4 v50, s[52:55], s37 offen nt lds
    s_add_u32 m0, m0, 1024
    s_add_u32 s37, s37, 73728
    buffer_load_dwordx4 v51, s[52:55], s37 offen nt lds
    ds_read_b64_tr_b16 v[80:81], v23 offset:36864
    ds_read_b64_tr_b16 v[82:83], v23 offset:37376
    s_waitcnt lgkmcnt(11)
    v_mfma_f32_16x16x32_bf16 v[40:43], v[100:103], v[88:91], v[40:43]
    s_waitcnt vmcnt(28)
    ds_read_b128 v[28:31], v16 offset:2688
    ds_read_b64_tr_b16 v[84:85], v20 offset:40960
    ds_read_b64_tr_b16 v[86:87], v20 offset:41472
    s_waitcnt lgkmcnt(12)
    v_mfma_f32_16x16x32_bf16 v[44:47], v[100:103], v[64:67], v[44:47]
    ds_read_b64_tr_b16 v[88:89], v21 offset:40960
    ds_read_b64_tr_b16 v[90:91], v21 offset:41472
    s_waitcnt lgkmcnt(11)
    v_mfma_f32_16x16x32_bf16 v[32:35], v[24:27], v[68:71], v[32:35]
    ds_read_b64_tr_b16 v[64:65], v22 offset:40960
    ds_read_b64_tr_b16 v[66:67], v22 offset:41472
    s_waitcnt lgkmcnt(11)
    v_mfma_f32_16x16x32_bf16 v[36:39], v[24:27], v[72:75], v[36:39]
    ds_read_b64_tr_b16 v[68:69], v23 offset:40960
    ds_read_b64_tr_b16 v[70:71], v23 offset:41472
    s_waitcnt lgkmcnt(11)
    v_mfma_f32_16x16x32_bf16 v[40:43], v[24:27], v[76:79], v[40:43]
    s_waitcnt vmcnt(24)
    ds_read_b128 v[100:103], v16 offset:2752
    ds_read_b64_tr_b16 v[72:73], v20 offset:45056
    ds_read_b64_tr_b16 v[74:75], v20 offset:45568
    s_waitcnt lgkmcnt(12)
    v_mfma_f32_16x16x32_bf16 v[44:47], v[24:27], v[80:83], v[44:47]
    ds_read_b64_tr_b16 v[76:77], v21 offset:45056
    ds_read_b64_tr_b16 v[78:79], v21 offset:45568
    s_waitcnt lgkmcnt(11)
    v_mfma_f32_16x16x32_bf16 v[32:35], v[28:31], v[84:87], v[32:35]
    ds_read_b64_tr_b16 v[80:81], v22 offset:45056
    ds_read_b64_tr_b16 v[82:83], v22 offset:45568
    s_waitcnt lgkmcnt(11)
    v_mfma_f32_16x16x32_bf16 v[36:39], v[28:31], v[88:91], v[36:39]
    ds_read_b64_tr_b16 v[84:85], v23 offset:45056
    ds_read_b64_tr_b16 v[86:87], v23 offset:45568
    s_waitcnt lgkmcnt(11)
    v_mfma_f32_16x16x32_bf16 v[40:43], v[28:31], v[64:67], v[40:43]
    s_waitcnt vmcnt(20)
    ds_read_b128 v[24:27], v16 offset:2816
    ds_read_b64_tr_b16 v[88:89], v20 offset:49152
    ds_read_b64_tr_b16 v[90:91], v20 offset:49664
    s_waitcnt lgkmcnt(12)
    v_mfma_f32_16x16x32_bf16 v[44:47], v[28:31], v[68:71], v[44:47]
    ds_read_b64_tr_b16 v[64:65], v21 offset:49152
    ds_read_b64_tr_b16 v[66:67], v21 offset:49664
    s_waitcnt lgkmcnt(11)
    v_mfma_f32_16x16x32_bf16 v[32:35], v[100:103], v[72:75], v[32:35]
    ds_read_b64_tr_b16 v[68:69], v22 offset:49152
    ds_read_b64_tr_b16 v[70:71], v22 offset:49664
    s_waitcnt lgkmcnt(11)
    v_mfma_f32_16x16x32_bf16 v[36:39], v[100:103], v[76:79], v[36:39]
    ds_read_b64_tr_b16 v[72:73], v23 offset:49152
    ds_read_b64_tr_b16 v[74:75], v23 offset:49664
    s_waitcnt lgkmcnt(11)
    v_mfma_f32_16x16x32_bf16 v[40:43], v[100:103], v[80:83], v[40:43]
    s_waitcnt vmcnt(16)
    ds_read_b128 v[28:31], v16 offset:2880
    ds_read_b64_tr_b16 v[76:77], v20 offset:53248
    ds_read_b64_tr_b16 v[78:79], v20 offset:53760
    s_waitcnt lgkmcnt(12)
    v_mfma_f32_16x16x32_bf16 v[44:47], v[100:103], v[84:87], v[44:47]
    ds_read_b64_tr_b16 v[80:81], v21 offset:53248
    ds_read_b64_tr_b16 v[82:83], v21 offset:53760
    s_waitcnt lgkmcnt(11)
    v_mfma_f32_16x16x32_bf16 v[32:35], v[24:27], v[88:91], v[32:35]
    ds_read_b64_tr_b16 v[84:85], v22 offset:53248
    ds_read_b64_tr_b16 v[86:87], v22 offset:53760
    s_waitcnt lgkmcnt(11)
    v_mfma_f32_16x16x32_bf16 v[36:39], v[24:27], v[64:67], v[36:39]
    ds_read_b64_tr_b16 v[88:89], v23 offset:53248
    ds_read_b64_tr_b16 v[90:91], v23 offset:53760
    s_waitcnt lgkmcnt(11)
    v_mfma_f32_16x16x32_bf16 v[40:43], v[24:27], v[68:71], v[40:43]
    s_waitcnt vmcnt(12)
    ds_read_b128 v[100:103], v16 offset:2944
    ds_read_b64_tr_b16 v[64:65], v20 offset:57344
    ds_read_b64_tr_b16 v[66:67], v20 offset:57856
    s_waitcnt lgkmcnt(12)
    v_mfma_f32_16x16x32_bf16 v[44:47], v[24:27], v[72:75], v[44:47]
    ds_read_b64_tr_b16 v[68:69], v21 offset:57344
    ds_read_b64_tr_b16 v[70:71], v21 offset:57856
    s_waitcnt lgkmcnt(11)
    v_mfma_f32_16x16x32_bf16 v[32:35], v[28:31], v[76:79], v[32:35]
    ds_read_b64_tr_b16 v[72:73], v22 offset:57344
    ds_read_b64_tr_b16 v[74:75], v22 offset:57856
    s_waitcnt lgkmcnt(11)
    v_mfma_f32_16x16x32_bf16 v[36:39], v[28:31], v[80:83], v[36:39]
    ds_read_b64_tr_b16 v[76:77], v23 offset:57344
    ds_read_b64_tr_b16 v[78:79], v23 offset:57856
    s_waitcnt lgkmcnt(11)
    v_mfma_f32_16x16x32_bf16 v[40:43], v[28:31], v[84:87], v[40:43]
    s_waitcnt vmcnt(8)
    ds_read_b128 v[24:27], v16 offset:3008
    ds_read_b64_tr_b16 v[80:81], v52 offset:0
    ds_read_b64_tr_b16 v[82:83], v52 offset:512
    s_waitcnt lgkmcnt(12)
    v_mfma_f32_16x16x32_bf16 v[44:47], v[28:31], v[88:91], v[44:47]
    ds_read_b64_tr_b16 v[84:85], v53 offset:0
    ds_read_b64_tr_b16 v[86:87], v53 offset:512
    s_waitcnt lgkmcnt(11)
    v_mfma_f32_16x16x32_bf16 v[32:35], v[100:103], v[64:67], v[32:35]
    ds_read_b64_tr_b16 v[88:89], v54 offset:0
    ds_read_b64_tr_b16 v[90:91], v54 offset:512
    s_waitcnt lgkmcnt(11)
    v_mfma_f32_16x16x32_bf16 v[36:39], v[100:103], v[68:71], v[36:39]
    ds_read_b64_tr_b16 v[64:65], v55 offset:0
    ds_read_b64_tr_b16 v[66:67], v55 offset:512
    s_waitcnt lgkmcnt(11)
    v_mfma_f32_16x16x32_bf16 v[40:43], v[100:103], v[72:75], v[40:43]
    s_waitcnt vmcnt(4)
    ds_read_b128 v[28:31], v16 offset:3072
    ds_read_b64_tr_b16 v[68:69], v52 offset:4096
    ds_read_b64_tr_b16 v[70:71], v52 offset:4608
    s_waitcnt lgkmcnt(12)
    v_mfma_f32_16x16x32_bf16 v[44:47], v[100:103], v[76:79], v[44:47]
    ds_read_b64_tr_b16 v[72:73], v53 offset:4096
    ds_read_b64_tr_b16 v[74:75], v53 offset:4608
    s_waitcnt lgkmcnt(11)
    v_mfma_f32_16x16x32_bf16 v[32:35], v[24:27], v[80:83], v[32:35]
    ds_read_b64_tr_b16 v[76:77], v54 offset:4096
    ds_read_b64_tr_b16 v[78:79], v54 offset:4608
    s_waitcnt lgkmcnt(11)
    v_mfma_f32_16x16x32_bf16 v[36:39], v[24:27], v[84:87], v[36:39]
    ds_read_b64_tr_b16 v[80:81], v55 offset:4096
    ds_read_b64_tr_b16 v[82:83], v55 offset:4608
    s_waitcnt lgkmcnt(11)
    v_mfma_f32_16x16x32_bf16 v[40:43], v[24:27], v[88:91], v[40:43]
    s_waitcnt vmcnt(0)
    ds_read_b128 v[100:103], v16 offset:3136
    ds_read_b64_tr_b16 v[84:85], v52 offset:8192
    ds_read_b64_tr_b16 v[86:87], v52 offset:8704
    s_waitcnt lgkmcnt(12)
    v_mfma_f32_16x16x32_bf16 v[44:47], v[24:27], v[64:67], v[44:47]
    ds_read_b64_tr_b16 v[88:89], v53 offset:8192
    ds_read_b64_tr_b16 v[90:91], v53 offset:8704
    s_waitcnt lgkmcnt(11)
    v_mfma_f32_16x16x32_bf16 v[32:35], v[28:31], v[68:71], v[32:35]
    ds_read_b64_tr_b16 v[64:65], v54 offset:8192
    ds_read_b64_tr_b16 v[66:67], v54 offset:8704
    s_waitcnt lgkmcnt(11)
    v_mfma_f32_16x16x32_bf16 v[36:39], v[28:31], v[72:75], v[36:39]
    ds_read_b64_tr_b16 v[68:69], v55 offset:8192
    ds_read_b64_tr_b16 v[70:71], v55 offset:8704
    s_waitcnt lgkmcnt(11)
    v_mfma_f32_16x16x32_bf16 v[40:43], v[28:31], v[76:79], v[40:43]
    s_waitcnt lgkmcnt(9)
    v_mfma_f32_16x16x32_bf16 v[44:47], v[28:31], v[80:83], v[44:47]
    s_waitcnt lgkmcnt(6)
    v_mfma_f32_16x16x32_bf16 v[32:35], v[100:103], v[84:87], v[32:35]
    s_waitcnt lgkmcnt(4)
    v_mfma_f32_16x16x32_bf16 v[36:39], v[100:103], v[88:91], v[36:39]
    s_waitcnt lgkmcnt(2)
    v_mfma_f32_16x16x32_bf16 v[40:43], v[100:103], v[64:67], v[40:43]
    s_waitcnt lgkmcnt(0)
    v_mfma_f32_16x16x32_bf16 v[44:47], v[100:103], v[68:71], v[44:47]
    ds_read_b32 v19, v1 offset:96
    v_and_b32 v17, 31, v0
    v_lshlrev_b32 v17, 4, v17
    s_nop 3
    v_max_f32 v24, 0, v32
    v_max_f32 v25, 0, v36
    v_max_f32 v26, 0, v40
    v_max_f32 v27, 0, v44
    v_bfi_b32 v24, s58, v24, v11
    v_bfi_b32 v25, s58, v25, v58
    v_bfi_b32 v26, s58, v26, v59
    v_bfi_b32 v27, s58, v27, v60
    s_mov_b32 exec_hi, 0
    v_add_u32 v18, 0x200000, v17
    global_store_dwordx4 v18, v[24:27], s[60:61]
    s_waitcnt lgkmcnt(0)
    v_readfirstlane_b32 s34, v19
    s_cmp_lg_u32 s34, 0
    s_cbranch_scc1 L_h_same
    global_store_dwordx4 v17, v[24:27], s[60:61] sc1
L_h_same:
    s_mov_b64 exec, -1
    v_mov_b32 v2, 1
    ds_write_b32 v1, v2 offset:76
L_fin:
L_end:
    s_endpgm
.section .rodata,"a"
.p2align 6
.amdhsa_kernel gated_mix__sliding_block_cached__dense_activation_relu__decode_kernel
  .amdhsa_next_free_vgpr 148
  .amdhsa_next_free_sgpr 96
  .amdhsa_accum_offset 148
  .amdhsa_group_segment_fixed_size 0
  .amdhsa_kernarg_size 96
  .amdhsa_user_sgpr_count 2
  .amdhsa_user_sgpr_kernarg_segment_ptr 1
  .amdhsa_system_sgpr_workgroup_id_x 1
.end_amdhsa_kernel
```
